```python
import torch

def _softmax(x, axis=-1):
    return torch.softmax(x, dim=axis)
def _gelu(x):
    return torch.nn.functional.gelu(x, approximate="tanh")
def _silu(x):
    return torch.nn.functional.silu(x)
def _sigmoid(x):
    return torch.sigmoid(x)
def _layernorm(x, axis=-1, eps=1e-5):
    m = x.mean(dim=axis, keepdim=True)
    v = x.var(dim=axis, keepdim=True, unbiased=False)
    return (x - m) / torch.sqrt(v + eps)
def _scatter_add(tgt, idx, src, axis=0):
    return tgt.clone().index_add_(axis, idx, src)
def _segment_sum(src, seg, n):
    out = torch.zeros((n,) + src.shape[1:], dtype=src.dtype)
    return out.index_add_(0, seg, src)
def _pad(x, pw):
    flat = tuple(v for pair in reversed(pw) for v in pair)
    return torch.nn.functional.pad(x, flat)

kernel_name = 'sequential_preLN__mha_block_cached__moe_arch_mod__decode'

def setup_inputs():

    _w = (lambda a: (lambda t: t.to(torch.bfloat16) if t.is_floating_point() else t)(torch.as_tensor(a)))
    def _A_setup():
        B, Sq, D = 1, 1, 640
        H, Sk, Dh = 32, 32768, 192
        return {
            "x": _w((lambda *s: torch.randn(*s, dtype=torch.bfloat16) * 0.05)(B, Sq, D)),
            "k_cache": _w((lambda *s: torch.randn(*s, dtype=torch.bfloat16) * 3.2)(B, H, Sk, Dh)),
            "v_cache": _w((lambda *s: torch.randn(*s, dtype=torch.bfloat16) * 0.4)(B, H, Sk, Dh)),
            "wq": _w((lambda *s: torch.randn(*s, dtype=torch.bfloat16) * 3.2)(D, H * Dh) * (D ** -0.5)),
            "wo": _w((lambda *s: torch.randn(*s, dtype=torch.bfloat16) * 0.4)(H * Dh, D) * ((H * Dh) ** -0.5)),
        }
    _A_in = _A_setup()

    def _B_setup():
        B, S, D, F, C = 1, 1, 640, 1536, 1
        return {
            "x": _w((lambda *s: torch.randn(*s, dtype=torch.bfloat16) * 0.05)(B, S, D)),
            "w_r": _w((lambda *s: torch.randn(*s, dtype=torch.bfloat16) * 0.05)(D)),
            "w_gate": _w((lambda *s: torch.randn(*s, dtype=torch.bfloat16) * 0.05)(D, F)),
            "w_up": _w((lambda *s: torch.randn(*s, dtype=torch.bfloat16) * 0.05)(D, F)),
            "w_down": _w((lambda *s: torch.randn(*s, dtype=torch.bfloat16) * 0.05)(F, D)),
        }
    _B_in = _B_setup()

    return {
        "A_x": _A_in["x"],
        "A_k_cache": _A_in["k_cache"],
        "A_v_cache": _A_in["v_cache"],
        "A_wq": _A_in["wq"],
        "A_wo": _A_in["wo"],
        "B_x": _B_in["x"],
        "B_w_r": _B_in["w_r"],
        "B_w_gate": _B_in["w_gate"],
        "B_w_up": _B_in["w_up"],
        "B_w_down": _B_in["w_down"],
    }

def reference(A_x, A_k_cache, A_v_cache, A_wq, A_wo, B_x, B_w_r, B_w_gate, B_w_up, B_w_down):
    def _A_ref(x, k_cache, v_cache, wq, wo):
        B, Sq, D = x.shape
        H, Dh = 32, 192
        q = (lambda x, *d: x.permute(*d))((x @ wq).reshape(B, Sq, H, Dh), 0, 2, 1, 3)
        scores = torch.einsum("bhqd,bhkd->bhqk", q, k_cache) * (Dh ** -0.5)
        p = _softmax(scores, axis=-1)
        o = torch.einsum("bhqk,bhkd->bhqd", p, v_cache)
        return (lambda x, *d: x.permute(*d))(o, 0, 2, 1, 3).reshape(B, Sq, H * Dh) @ wo

    def _B_ref(x, w_r, w_gate, w_up, w_down):
        B, S, D = x.shape
        C = 1
        r = x @ w_r
        idx = torch.argsort(-r, axis=-1)[:, :C]
        idx_e = (lambda x, n, axis: torch.repeat_interleave(x, n, dim=axis))(idx.reshape(B, C, 1), D, axis=2)
        x_sel = (lambda x, i, axis: torch.take_along_dim(x, i, dim=axis))(x, idx_e, axis=1)
        g = _silu(x_sel @ w_gate)
        u = x_sel @ w_up
        y = (g * u) @ w_down
        r_sel = _sigmoid((lambda x, i, axis: torch.take_along_dim(x, i, dim=axis))(r, idx, axis=1))
        y = y * r_sel.reshape(B, C, 1)
        b_off = (torch.arange(B) * S).reshape(B, 1)
        flat_idx = (idx + b_off).reshape(B * C)
        zero = (x * 0.0).reshape(B * S, D)
        upd = _scatter_add(zero, flat_idx, y.reshape(B * C, D), axis=0)
        return x + upd.reshape(B, S, D)

    x = A_x
    h = x + _A_ref(_layernorm(x, axis=-1), A_k_cache, A_v_cache, A_wq, A_wo)
    h2 = h + _B_ref(_layernorm(h, axis=-1), B_w_r, B_w_gate, B_w_up, B_w_down)
    return h2
```

```asm
; @launch grid=(256,1,1) block=(320,1,1) lds=48128
.amdgcn_target "amdgcn-amd-amdhsa--gfx950"
.text
.globl sequential_preLN__mha_block_cached__moe_arch_mod__decode_kernel
.p2align 8
.type sequential_preLN__mha_block_cached__moe_arch_mod__decode_kernel,@function
sequential_preLN__mha_block_cached__moe_arch_mod__decode_kernel:
  s_cmp_ge_u32 s2, 256
  s_cbranch_scc1 L_end
  s_load_dwordx16 s[4:19], s[0:1], 0
  s_load_dwordx8 s[20:27], s[0:1], 64
  s_load_dwordx2 s[28:29], s[0:1], 96
  v_and_b32 v1, 63, v0
  v_lshrrev_b32 v41, 6, v0
  v_lshrrev_b32 v43, 3, v1
  v_readfirstlane_b32 s3, v41
  v_and_b32 v44, 7, v1
  v_lshlrev_b32 v45, 4, v44
  s_cmp_lg_u32 s3, 4
  s_nop 1
  s_cbranch_scc1 L_stream
  s_setprio 3
  s_and_b32 s57, s2, 31
  s_lshr_b32 s58, s2, 5
  v_mul_u32_u24 v47, 12288, v43
  s_mul_i32 s59, s57, 384
  v_add3_u32 v47, v47, v45, s59
  s_mul_i32 s60, s58, 983040
  v_lshlrev_b32 v42, 3, v1
  v_add_u32 v46, 1024, v42
  v_min_u32 v46, 1272, v46
  s_mov_b32 s42, 7864320
  s_mov_b32 s43, 0x20000
  s_waitcnt lgkmcnt(0)
  s_mov_b32 s40, s10
  s_mov_b32 s41, s11
  global_load_dwordx2 v[168:169], v42, s[4:5]
  global_load_dwordx2 v[170:171], v42, s[4:5] offset:512
  global_load_dwordx2 v[172:173], v46, s[4:5]
  buffer_load_dwordx4 v[48:51], v47, s[40:43], s60 offen offset:0 nt
  buffer_load_dwordx4 v[52:55], v47, s[40:43], s60 offen offset:128 nt
  buffer_load_dwordx4 v[56:59], v47, s[40:43], s60 offen offset:256 nt
  s_add_u32 s60, s60, 98304
  buffer_load_dwordx4 v[60:63], v47, s[40:43], s60 offen offset:0 nt
  buffer_load_dwordx4 v[64:67], v47, s[40:43], s60 offen offset:128 nt
  buffer_load_dwordx4 v[68:71], v47, s[40:43], s60 offen offset:256 nt
  s_add_u32 s60, s60, 98304
  buffer_load_dwordx4 v[72:75], v47, s[40:43], s60 offen offset:0 nt
  buffer_load_dwordx4 v[76:79], v47, s[40:43], s60 offen offset:128 nt
  buffer_load_dwordx4 v[80:83], v47, s[40:43], s60 offen offset:256 nt
  s_add_u32 s60, s60, 98304
  buffer_load_dwordx4 v[84:87], v47, s[40:43], s60 offen offset:0 nt
  buffer_load_dwordx4 v[88:91], v47, s[40:43], s60 offen offset:128 nt
  buffer_load_dwordx4 v[92:95], v47, s[40:43], s60 offen offset:256 nt
  s_add_u32 s60, s60, 98304
  buffer_load_dwordx4 v[96:99], v47, s[40:43], s60 offen offset:0 nt
  buffer_load_dwordx4 v[100:103], v47, s[40:43], s60 offen offset:128 nt
  buffer_load_dwordx4 v[104:107], v47, s[40:43], s60 offen offset:256 nt
  s_add_u32 s60, s60, 98304
  buffer_load_dwordx4 v[108:111], v47, s[40:43], s60 offen offset:0 nt
  buffer_load_dwordx4 v[112:115], v47, s[40:43], s60 offen offset:128 nt
  buffer_load_dwordx4 v[116:119], v47, s[40:43], s60 offen offset:256 nt
  s_add_u32 s60, s60, 98304
  buffer_load_dwordx4 v[120:123], v47, s[40:43], s60 offen offset:0 nt
  buffer_load_dwordx4 v[124:127], v47, s[40:43], s60 offen offset:128 nt
  buffer_load_dwordx4 v[128:131], v47, s[40:43], s60 offen offset:256 nt
  s_add_u32 s60, s60, 98304
  buffer_load_dwordx4 v[132:135], v47, s[40:43], s60 offen offset:0 nt
  buffer_load_dwordx4 v[136:139], v47, s[40:43], s60 offen offset:128 nt
  buffer_load_dwordx4 v[140:143], v47, s[40:43], s60 offen offset:256 nt
  s_add_u32 s60, s60, 98304
  buffer_load_dwordx4 v[144:147], v47, s[40:43], s60 offen offset:0 nt
  buffer_load_dwordx4 v[148:151], v47, s[40:43], s60 offen offset:128 nt
  buffer_load_dwordx4 v[152:155], v47, s[40:43], s60 offen offset:256 nt
  s_add_u32 s60, s60, 98304
  buffer_load_dwordx4 v[156:159], v47, s[40:43], s60 offen offset:0 nt
  buffer_load_dwordx4 v[160:163], v47, s[40:43], s60 offen offset:128 nt
  buffer_load_dwordx4 v[164:167], v47, s[40:43], s60 offen offset:256 nt
  s_barrier
  s_getpc_b64 s[58:59]
L_pc:
  s_lshr_b32 s60, s2, 3
  s_lshl_b32 s60, s60, 9
  v_and_b32 v41, 7, v1
  v_lshlrev_b32 v41, 6, v41
  v_add_u32 v41, s60, v41
  v_add_u32 v41, L_kcode-L_pc, v41
  v_min_u32 v41, L_codeend-L_pc-4, v41
  global_load_dword v225, v41, s[58:59]
  v_mov_b32 v232, 0
  ds_write_b32 v232, v232 offset:2048
  ds_write_b32 v232, v232 offset:2052
  ds_write_b32 v232, v232 offset:2056
  ds_write_b32 v232, v232 offset:2060
  ds_write_b32 v232, v232 offset:2064
  ds_write_b32 v232, v232 offset:2068
  ds_write_b32 v232, v232 offset:2072
  ds_write_b32 v232, v232 offset:2076
  ds_write_b32 v232, v232 offset:2080
  s_load_dword s49, s[28:29], 0
  v_mov_b32 v4, 0
  v_mov_b32 v46, 0xffff
  v_cmp_eq_u32 vcc, 0, v44
  s_nop 1
  v_cndmask_b32 v4, v4, v46, vcc
  v_mov_b32 v46, 0xffff0000
  v_cmp_eq_u32 vcc, 1, v44
  s_nop 1
  v_cndmask_b32 v4, v4, v46, vcc
  v_mov_b32 v5, 0
  v_mov_b32 v46, 0xffff
  v_cmp_eq_u32 vcc, 2, v44
  s_nop 1
  v_cndmask_b32 v5, v5, v46, vcc
  v_mov_b32 v46, 0xffff0000
  v_cmp_eq_u32 vcc, 3, v44
  s_nop 1
  v_cndmask_b32 v5, v5, v46, vcc
  v_mov_b32 v6, 0
  v_mov_b32 v46, 0xffff
  v_cmp_eq_u32 vcc, 4, v44
  s_nop 1
  v_cndmask_b32 v6, v6, v46, vcc
  v_mov_b32 v46, 0xffff0000
  v_cmp_eq_u32 vcc, 5, v44
  s_nop 1
  v_cndmask_b32 v6, v6, v46, vcc
  v_mov_b32 v7, 0
  v_mov_b32 v46, 0xffff
  v_cmp_eq_u32 vcc, 6, v44
  s_nop 1
  v_cndmask_b32 v7, v7, v46, vcc
  v_mov_b32 v46, 0xffff0000
  v_cmp_eq_u32 vcc, 7, v44
  s_nop 1
  v_cndmask_b32 v7, v7, v46, vcc
  s_mov_b32 s36, s28
  s_mov_b32 s37, s29
  s_mov_b32 s38, 2097152
  s_mov_b32 s39, 0x20000
  s_and_b32 s78, s2, 7
  s_waitcnt vmcnt(31)
  s_waitcnt lgkmcnt(0)
  s_add_u32 s49, s49, 0x9e3779b9
  v_mov_b32 v3, s49
  s_getreg_b32 s57, hwreg(HW_REG_XCC_ID, 0, 4)
  s_and_b32 s50, s57, 1
  s_and_b32 s58, s49, 0xfffffff0
  s_or_b32 s57, s57, s58
  v_mov_b32 v198, s57
  s_and_b32 s87, s2, 7
  s_lshl_b32 s87, s87, 7
  s_lshr_b32 s58, s2, 3
  s_lshl_b32 s58, s58, 2
  s_add_u32 s58, s58, s87
  s_add_u32 s58, s58, 1835008
  s_mov_b64 exec, 1
  buffer_store_dword v198, v232, s[36:39], s58 offen
  s_mov_b64 exec, -1
  v_cmp_gt_u32 vcc, 32, v1
  s_nop 1
  v_cndmask_b32 v172, 0, v172, vcc
  v_cndmask_b32 v173, 0, v173, vcc
  v_lshlrev_b32 v176, 16, v168
  v_and_b32 v177, 0xffff0000, v168
  v_lshlrev_b32 v178, 16, v169
  v_and_b32 v179, 0xffff0000, v169
  v_lshlrev_b32 v180, 16, v170
  v_and_b32 v181, 0xffff0000, v170
  v_lshlrev_b32 v182, 16, v171
  v_and_b32 v183, 0xffff0000, v171
  v_lshlrev_b32 v184, 16, v172
  v_and_b32 v185, 0xffff0000, v172
  v_lshlrev_b32 v186, 16, v173
  v_and_b32 v187, 0xffff0000, v173
  v_mov_b32 v45, 0x3f803f80
  v_dot2_f32_bf16 v41, v168, v45, 0
  v_dot2_f32_bf16 v42, v168, v168, 0
  v_dot2_f32_bf16 v41, v169, v45, v41
  v_dot2_f32_bf16 v42, v169, v169, v42
  v_dot2_f32_bf16 v41, v170, v45, v41
  v_dot2_f32_bf16 v42, v170, v170, v42
  v_dot2_f32_bf16 v41, v171, v45, v41
  v_dot2_f32_bf16 v42, v171, v171, v42
  v_dot2_f32_bf16 v41, v172, v45, v41
  v_dot2_f32_bf16 v42, v172, v172, v42
  v_dot2_f32_bf16 v41, v173, v45, v41
  v_dot2_f32_bf16 v42, v173, v173, v42
  s_nop 1
  v_add_f32_dpp v41, v41, v41 quad_perm:[1,0,3,2] row_mask:0xf bank_mask:0xf
  v_add_f32_dpp v42, v42, v42 quad_perm:[1,0,3,2] row_mask:0xf bank_mask:0xf
  s_nop 0
  v_add_f32_dpp v41, v41, v41 quad_perm:[2,3,0,1] row_mask:0xf bank_mask:0xf
  v_add_f32_dpp v42, v42, v42 quad_perm:[2,3,0,1] row_mask:0xf bank_mask:0xf
  s_nop 0
  v_add_f32_dpp v41, v41, v41 row_half_mirror row_mask:0xf bank_mask:0xf
  v_add_f32_dpp v42, v42, v42 row_half_mirror row_mask:0xf bank_mask:0xf
  s_nop 0
  v_add_f32_dpp v41, v41, v41 row_mirror row_mask:0xf bank_mask:0xf
  v_add_f32_dpp v42, v42, v42 row_mirror row_mask:0xf bank_mask:0xf
  v_mov_b32 v43, v41
  v_mov_b32 v44, v42
  s_nop 0
  v_permlane16_swap_b32 v43, v41
  v_permlane16_swap_b32 v44, v42
  v_add_f32 v41, v41, v43
  v_add_f32 v42, v42, v44
  v_mov_b32 v43, v41
  v_mov_b32 v44, v42
  s_nop 0
  v_permlane32_swap_b32 v43, v41
  v_permlane32_swap_b32 v44, v42
  v_add_f32 v41, v41, v43
  v_add_f32 v42, v42, v44
  v_mul_f32 v41, 0x3acccccd, v41
  v_mul_f32 v42, 0x3acccccd, v42
  v_fma_f32 v42, -v41, v41, v42
  v_max_f32 v42, 0, v42
  v_cvt_pk_bf16_f32 v42, v42, v42
  v_lshlrev_b32 v42, 16, v42
  v_add_f32 v42, 0x3727c5ac, v42
  v_cvt_pk_bf16_f32 v42, v42, v42
  v_lshlrev_b32 v42, 16, v42
  v_cvt_pk_bf16_f32 v41, v41, v41
  v_lshlrev_b32 v41, 16, v41
  v_sqrt_f32 v42, v42
  s_nop 0
  v_cvt_pk_bf16_f32 v42, v42, v42
  v_lshlrev_b32 v42, 16, v42
  v_rcp_f32 v45, v42
  v_sub_f32 v176, v176, v41
  v_sub_f32 v177, v177, v41
  v_cvt_pk_bf16_f32 v43, v176, v177
  v_lshlrev_b32 v176, 16, v43
  v_and_b32 v177, 0xffff0000, v43
  v_mul_f32 v43, v176, v45
  v_fma_f32 v44, -v43, v42, v176
  v_fma_f32 v176, v44, v45, v43
  v_mul_f32 v43, v177, v45
  v_fma_f32 v44, -v43, v42, v177
  v_fma_f32 v177, v44, v45, v43
  v_cvt_pk_bf16_f32 v168, v176, v177
  v_lshlrev_b32 v176, 16, v168
  v_and_b32 v177, 0xffff0000, v168
  v_sub_f32 v178, v178, v41
  v_sub_f32 v179, v179, v41
  v_cvt_pk_bf16_f32 v43, v178, v179
  v_lshlrev_b32 v178, 16, v43
  v_and_b32 v179, 0xffff0000, v43
  v_mul_f32 v43, v178, v45
  v_fma_f32 v44, -v43, v42, v178
  v_fma_f32 v178, v44, v45, v43
  v_mul_f32 v43, v179, v45
  v_fma_f32 v44, -v43, v42, v179
  v_fma_f32 v179, v44, v45, v43
  v_cvt_pk_bf16_f32 v169, v178, v179
  v_lshlrev_b32 v178, 16, v169
  v_and_b32 v179, 0xffff0000, v169
  v_sub_f32 v180, v180, v41
  v_sub_f32 v181, v181, v41
  v_cvt_pk_bf16_f32 v43, v180, v181
  v_lshlrev_b32 v180, 16, v43
  v_and_b32 v181, 0xffff0000, v43
  v_mul_f32 v43, v180, v45
  v_fma_f32 v44, -v43, v42, v180
  v_fma_f32 v180, v44, v45, v43
  v_mul_f32 v43, v181, v45
  v_fma_f32 v44, -v43, v42, v181
  v_fma_f32 v181, v44, v45, v43
  v_cvt_pk_bf16_f32 v170, v180, v181
  v_lshlrev_b32 v180, 16, v170
  v_and_b32 v181, 0xffff0000, v170
  v_sub_f32 v182, v182, v41
  v_sub_f32 v183, v183, v41
  v_cvt_pk_bf16_f32 v43, v182, v183
  v_lshlrev_b32 v182, 16, v43
  v_and_b32 v183, 0xffff0000, v43
  v_mul_f32 v43, v182, v45
  v_fma_f32 v44, -v43, v42, v182
  v_fma_f32 v182, v44, v45, v43
  v_mul_f32 v43, v183, v45
  v_fma_f32 v44, -v43, v42, v183
  v_fma_f32 v183, v44, v45, v43
  v_cvt_pk_bf16_f32 v171, v182, v183
  v_lshlrev_b32 v182, 16, v171
  v_and_b32 v183, 0xffff0000, v171
  v_sub_f32 v184, v184, v41
  v_sub_f32 v185, v185, v41
  v_cvt_pk_bf16_f32 v43, v184, v185
  v_lshlrev_b32 v184, 16, v43
  v_and_b32 v185, 0xffff0000, v43
  v_mul_f32 v43, v184, v45
  v_fma_f32 v44, -v43, v42, v184
  v_fma_f32 v184, v44, v45, v43
  v_mul_f32 v43, v185, v45
  v_fma_f32 v44, -v43, v42, v185
  v_fma_f32 v185, v44, v45, v43
  v_cvt_pk_bf16_f32 v172, v184, v185
  v_lshlrev_b32 v184, 16, v172
  v_and_b32 v185, 0xffff0000, v172
  v_sub_f32 v186, v186, v41
  v_sub_f32 v187, v187, v41
  v_cvt_pk_bf16_f32 v43, v186, v187
  v_lshlrev_b32 v186, 16, v43
  v_and_b32 v187, 0xffff0000, v43
  v_mul_f32 v43, v186, v45
  v_fma_f32 v44, -v43, v42, v186
  v_fma_f32 v186, v44, v45, v43
  v_mul_f32 v43, v187, v45
  v_fma_f32 v44, -v43, v42, v187
  v_fma_f32 v187, v44, v45, v43
  v_cvt_pk_bf16_f32 v173, v186, v187
  v_lshlrev_b32 v186, 16, v173
  v_and_b32 v187, 0xffff0000, v173
  v_lshlrev_b32 v41, 3, v1
  ds_write_b64 v41, v[168:169] offset:0
  ds_write_b64 v41, v[170:171] offset:512
  s_mov_b32 exec_lo, 0xffffffff
  s_mov_b32 exec_hi, 0x00000000
  ds_write_b64 v41, v[172:173] offset:1024
  s_mov_b64 exec, -1
  s_lshr_b32 s58, s2, 5
  s_mul_i32 s58, s58, 160
  v_lshrrev_b32 v41, 3, v1
  v_lshlrev_b32 v41, 1, v41
  v_add_u32 v41, s58, v41
  s_waitcnt lgkmcnt(0)
  ds_read_u16 v188, v41 offset:0
  ds_read_u16 v189, v41 offset:16
  ds_read_u16 v190, v41 offset:32
  ds_read_u16 v191, v41 offset:48
  ds_read_u16 v192, v41 offset:64
  ds_read_u16 v193, v41 offset:80
  ds_read_u16 v194, v41 offset:96
  ds_read_u16 v195, v41 offset:112
  ds_read_u16 v196, v41 offset:128
  ds_read_u16 v197, v41 offset:144
  v_mov_b32 v24, 0
  v_mov_b32 v25, 0
  v_mov_b32 v26, 0
  v_mov_b32 v27, 0
  v_mov_b32 v28, 0
  v_mov_b32 v29, 0
  v_mov_b32 v30, 0
  v_mov_b32 v31, 0
  v_mov_b32 v32, 0
  v_mov_b32 v33, 0
  v_mov_b32 v34, 0
  v_mov_b32 v35, 0
  s_waitcnt lgkmcnt(0)
  v_lshl_or_b32 v188, v188, 16, v188
  v_lshl_or_b32 v189, v189, 16, v189
  v_lshl_or_b32 v190, v190, 16, v190
  v_lshl_or_b32 v191, v191, 16, v191
  v_lshl_or_b32 v192, v192, 16, v192
  v_lshl_or_b32 v193, v193, 16, v193
  v_lshl_or_b32 v194, v194, 16, v194
  v_lshl_or_b32 v195, v195, 16, v195
  v_lshl_or_b32 v196, v196, 16, v196
  v_lshl_or_b32 v197, v197, 16, v197
  v_and_b32 v8, v188, v4
  v_and_b32 v9, v188, v5
  v_and_b32 v10, v188, v6
  v_and_b32 v11, v188, v7
  s_waitcnt vmcnt(29)
  s_nop 0
  v_mfma_f32_16x16x32_bf16 v[24:27], v[8:11], v[48:51], v[24:27]
  v_mfma_f32_16x16x32_bf16 v[28:31], v[8:11], v[52:55], v[28:31]
  v_mfma_f32_16x16x32_bf16 v[32:35], v[8:11], v[56:59], v[32:35]
  v_and_b32 v8, v189, v4
  v_and_b32 v9, v189, v5
  v_and_b32 v10, v189, v6
  v_and_b32 v11, v189, v7
  s_waitcnt vmcnt(26)
  s_nop 0
  v_mfma_f32_16x16x32_bf16 v[24:27], v[8:11], v[60:63], v[24:27]
  v_mfma_f32_16x16x32_bf16 v[28:31], v[8:11], v[64:67], v[28:31]
  v_mfma_f32_16x16x32_bf16 v[32:35], v[8:11], v[68:71], v[32:35]
  v_and_b32 v8, v190, v4
  v_and_b32 v9, v190, v5
  v_and_b32 v10, v190, v6
  v_and_b32 v11, v190, v7
  s_waitcnt vmcnt(23)
  s_nop 0
  v_mfma_f32_16x16x32_bf16 v[24:27], v[8:11], v[72:75], v[24:27]
  v_mfma_f32_16x16x32_bf16 v[28:31], v[8:11], v[76:79], v[28:31]
  v_mfma_f32_16x16x32_bf16 v[32:35], v[8:11], v[80:83], v[32:35]
  v_and_b32 v8, v191, v4
  v_and_b32 v9, v191, v5
  v_and_b32 v10, v191, v6
  v_and_b32 v11, v191, v7
  s_waitcnt vmcnt(20)
  s_nop 0
  v_mfma_f32_16x16x32_bf16 v[24:27], v[8:11], v[84:87], v[24:27]
  v_mfma_f32_16x16x32_bf16 v[28:31], v[8:11], v[88:91], v[28:31]
  v_mfma_f32_16x16x32_bf16 v[32:35], v[8:11], v[92:95], v[32:35]
  v_and_b32 v8, v192, v4
  v_and_b32 v9, v192, v5
  v_and_b32 v10, v192, v6
  v_and_b32 v11, v192, v7
  s_waitcnt vmcnt(17)
  s_nop 0
  v_mfma_f32_16x16x32_bf16 v[24:27], v[8:11], v[96:99], v[24:27]
  v_mfma_f32_16x16x32_bf16 v[28:31], v[8:11], v[100:103], v[28:31]
  v_mfma_f32_16x16x32_bf16 v[32:35], v[8:11], v[104:107], v[32:35]
  v_and_b32 v8, v193, v4
  v_and_b32 v9, v193, v5
  v_and_b32 v10, v193, v6
  v_and_b32 v11, v193, v7
  s_waitcnt vmcnt(14)
  s_nop 0
  v_mfma_f32_16x16x32_bf16 v[24:27], v[8:11], v[108:111], v[24:27]
  v_mfma_f32_16x16x32_bf16 v[28:31], v[8:11], v[112:115], v[28:31]
  v_mfma_f32_16x16x32_bf16 v[32:35], v[8:11], v[116:119], v[32:35]
  v_and_b32 v8, v194, v4
  v_and_b32 v9, v194, v5
  v_and_b32 v10, v194, v6
  v_and_b32 v11, v194, v7
  s_waitcnt vmcnt(11)
  s_nop 0
  v_mfma_f32_16x16x32_bf16 v[24:27], v[8:11], v[120:123], v[24:27]
  v_mfma_f32_16x16x32_bf16 v[28:31], v[8:11], v[124:127], v[28:31]
  v_mfma_f32_16x16x32_bf16 v[32:35], v[8:11], v[128:131], v[32:35]
  v_and_b32 v8, v195, v4
  v_and_b32 v9, v195, v5
  v_and_b32 v10, v195, v6
  v_and_b32 v11, v195, v7
  s_waitcnt vmcnt(8)
  s_nop 0
  v_mfma_f32_16x16x32_bf16 v[24:27], v[8:11], v[132:135], v[24:27]
  v_mfma_f32_16x16x32_bf16 v[28:31], v[8:11], v[136:139], v[28:31]
  v_mfma_f32_16x16x32_bf16 v[32:35], v[8:11], v[140:143], v[32:35]
  v_and_b32 v8, v196, v4
  v_and_b32 v9, v196, v5
  v_and_b32 v10, v196, v6
  v_and_b32 v11, v196, v7
  v_and_b32 v46, 31, v1
  v_lshlrev_b32 v46, 2, v46
  s_add_u32 s59, s87, 1835008
  buffer_load_dword v199, v46, s[36:39], s59 offen sc1
  s_waitcnt vmcnt(6)
  v_mfma_f32_16x16x32_bf16 v[24:27], v[8:11], v[144:147], v[24:27]
  v_mfma_f32_16x16x32_bf16 v[28:31], v[8:11], v[148:151], v[28:31]
  v_mfma_f32_16x16x32_bf16 v[32:35], v[8:11], v[152:155], v[32:35]
  v_and_b32 v8, v197, v4
  v_and_b32 v9, v197, v5
  v_and_b32 v10, v197, v6
  v_and_b32 v11, v197, v7
  s_waitcnt vmcnt(3)
  s_nop 0
  v_mfma_f32_16x16x32_bf16 v[24:27], v[8:11], v[156:159], v[24:27]
  v_mfma_f32_16x16x32_bf16 v[28:31], v[8:11], v[160:163], v[28:31]
  v_mfma_f32_16x16x32_bf16 v[32:35], v[8:11], v[164:167], v[32:35]
  v_lshrrev_b32 v41, 5, v1
  v_mul_u32_u24 v226, 768, v41
  v_and_b32 v41, 7, v1
  v_lshlrev_b32 v41, 5, v41
  v_add_u32 v226, v226, v41
  v_and_b32 v41, 16, v1
  v_add_u32 v226, v226, v41
  v_mul_u32_u24 v41, 12, v1
  s_and_b32 s57, s2, 31
  s_lshr_b32 s58, s2, 5
  s_lshl_b32 s57, s57, 3
  s_add_u32 s57, s57, s58
  s_lshl_b32 s57, s57, 10
  s_add_u32 s57, s57, 4096
  v_lshlrev_b32 v42, 4, v1
  s_mov_b32 exec_lo, 0x00FF00FF
  s_mov_b32 exec_hi, 0xFF00FF00
  ds_write_b128 v226, v[24:27] offset:6656
  ds_write_b128 v226, v[28:31] offset:6912
  ds_write_b128 v226, v[32:35] offset:7168
  s_mov_b64 exec, -1
  s_waitcnt lgkmcnt(0)
  ds_read_b32 v200, v41 offset:6656
  ds_read_b32 v201, v41 offset:6660
  ds_read_b32 v202, v41 offset:6664
  ds_read_b32 v204, v41 offset:7424
  ds_read_b32 v205, v41 offset:7428
  ds_read_b32 v206, v41 offset:7432
  s_waitcnt lgkmcnt(0)
  v_pk_add_f32 v[200:201], v[200:201], v[204:205]
  v_add_f32 v202, v202, v206
  v_mov_b32 v203, v3
  s_mov_b32 s30, 0
  s_mov_b32 s81, 8
  s_waitcnt vmcnt(0)
L_clschk:
  v_cmp_ne_u32 vcc, v199, v198
  s_cmp_eq_u64 vcc, 0
  s_cselect_b32 s30, 1, 0
  s_nop 2
  s_cbranch_scc1 L_clsdone
  s_sub_u32 s81, s81, 1
  s_cmp_eq_u32 s81, 0
  s_cbranch_scc1 L_clsdone
  v_and_b32 v46, 31, v1
  v_lshlrev_b32 v46, 2, v46
  s_add_u32 s59, s87, 1835008
  buffer_load_dword v199, v46, s[36:39], s59 offen sc1
  s_waitcnt vmcnt(0)
  s_branch L_clschk
L_clsdone:
  s_cmp_eq_u32 s30, 1
  s_cbranch_scc1 L_pl1
  buffer_store_dwordx4 v[200:203], v42, s[36:39], s57 offen sc1
  s_nop 1
  s_branch L_pd1
L_pl1:
  buffer_store_dwordx4 v[200:203], v42, s[36:39], s57 offen
  s_nop 1
L_pd1:
  v_mov_b32 v43, s30
  ds_write_b32 v232, v43 offset:2056
  s_add_u32 s86, s78, 0
  s_lshl_b32 s86, s86, 13
  s_add_u32 s86, s86, 4096
  s_mov_b32 s81, 524288
  s_add_u32 s58, s86, 0
  buffer_load_dwordx4 v[48:51], v42, s[36:39], s58 offen sc1
  s_add_u32 s58, s86, 1024
  buffer_load_dwordx4 v[52:55], v42, s[36:39], s58 offen sc1
  s_add_u32 s58, s86, 2048
  buffer_load_dwordx4 v[56:59], v42, s[36:39], s58 offen sc1
  s_add_u32 s58, s86, 3072
  buffer_load_dwordx4 v[60:63], v42, s[36:39], s58 offen sc1
  s_add_u32 s58, s86, 4096
  buffer_load_dwordx4 v[64:67], v42, s[36:39], s58 offen sc1
  s_add_u32 s58, s86, 5120
  buffer_load_dwordx4 v[68:71], v42, s[36:39], s58 offen sc1
  s_add_u32 s58, s86, 6144
  buffer_load_dwordx4 v[72:75], v42, s[36:39], s58 offen sc1
  s_add_u32 s58, s86, 7168
  buffer_load_dwordx4 v[76:79], v42, s[36:39], s58 offen sc1
  s_waitcnt vmcnt(0)
  s_branch L_pollchk2
L_poll2:
  s_sub_u32 s81, s81, 1
  s_cmp_eq_u32 s81, 0
  s_cbranch_scc1 L_abort
  s_add_u32 s58, s86, 0
  buffer_load_dwordx4 v[48:51], v42, s[36:39], s58 offen sc1
  s_add_u32 s58, s86, 1024
  buffer_load_dwordx4 v[52:55], v42, s[36:39], s58 offen sc1
  s_add_u32 s58, s86, 2048
  buffer_load_dwordx4 v[56:59], v42, s[36:39], s58 offen sc1
  s_add_u32 s58, s86, 3072
  buffer_load_dwordx4 v[60:63], v42, s[36:39], s58 offen sc1
  s_add_u32 s58, s86, 4096
  buffer_load_dwordx4 v[64:67], v42, s[36:39], s58 offen sc1
  s_add_u32 s58, s86, 5120
  buffer_load_dwordx4 v[68:71], v42, s[36:39], s58 offen sc1
  s_add_u32 s58, s86, 6144
  buffer_load_dwordx4 v[72:75], v42, s[36:39], s58 offen sc1
  s_add_u32 s58, s86, 7168
  buffer_load_dwordx4 v[76:79], v42, s[36:39], s58 offen sc1
  s_waitcnt vmcnt(0)
L_pollchk2:
  v_cmp_ne_u32 vcc, v51, v3
  s_mov_b64 s[84:85], vcc
  v_cmp_ne_u32 vcc, v55, v3
  s_or_b64 s[84:85], s[84:85], vcc
  v_cmp_ne_u32 vcc, v59, v3
  s_or_b64 s[84:85], s[84:85], vcc
  v_cmp_ne_u32 vcc, v63, v3
  s_or_b64 s[84:85], s[84:85], vcc
  v_cmp_ne_u32 vcc, v67, v3
  s_or_b64 s[84:85], s[84:85], vcc
  v_cmp_ne_u32 vcc, v71, v3
  s_or_b64 s[84:85], s[84:85], vcc
  v_cmp_ne_u32 vcc, v75, v3
  s_or_b64 s[84:85], s[84:85], vcc
  v_cmp_ne_u32 vcc, v79, v3
  s_or_b64 s[84:85], s[84:85], vcc
  s_cmp_lg_u64 s[84:85], 0
  s_nop 2
  s_cbranch_scc1 L_poll2
  v_pk_add_f32 v[48:49], v[48:49], v[52:53]
  v_add_f32 v50, v50, v54
  v_pk_add_f32 v[48:49], v[48:49], v[56:57]
  v_add_f32 v50, v50, v58
  v_pk_add_f32 v[48:49], v[48:49], v[60:61]
  v_add_f32 v50, v50, v62
  v_pk_add_f32 v[48:49], v[48:49], v[64:65]
  v_add_f32 v50, v50, v66
  v_pk_add_f32 v[48:49], v[48:49], v[68:69]
  v_add_f32 v50, v50, v70
  v_pk_add_f32 v[48:49], v[48:49], v[72:73]
  v_add_f32 v50, v50, v74
  v_pk_add_f32 v[48:49], v[48:49], v[76:77]
  v_add_f32 v50, v50, v78
  v_cvt_pk_bf16_f32 v48, v48, v49
  v_cvt_pk_bf16_f32 v50, v50, v50
  v_mul_u32_u24 v41, 6, v1
  ds_write_b16 v41, v48 offset:5120
  ds_write_b16_d16_hi v41, v48 offset:5122
  ds_write_b16 v41, v50 offset:5124
  s_waitcnt lgkmcnt(0)
  v_mov_b32 v41, 1
  ds_write_b32 v232, v41 offset:2080
  s_waitcnt lgkmcnt(0)
  s_barrier
  s_add_u32 s86, s78, 8
  s_lshl_b32 s86, s86, 13
  s_add_u32 s86, s86, 4096
  s_mov_b32 s81, 524288
  s_add_u32 s58, s86, 0
  buffer_load_dwordx4 v[48:51], v42, s[36:39], s58 offen sc1
  s_add_u32 s58, s86, 1024
  buffer_load_dwordx4 v[52:55], v42, s[36:39], s58 offen sc1
  s_add_u32 s58, s86, 2048
  buffer_load_dwordx4 v[56:59], v42, s[36:39], s58 offen sc1
  s_add_u32 s58, s86, 3072
  buffer_load_dwordx4 v[60:63], v42, s[36:39], s58 offen sc1
  s_add_u32 s58, s86, 4096
  buffer_load_dwordx4 v[64:67], v42, s[36:39], s58 offen sc1
  s_add_u32 s58, s86, 5120
  buffer_load_dwordx4 v[68:71], v42, s[36:39], s58 offen sc1
  s_add_u32 s58, s86, 6144
  buffer_load_dwordx4 v[72:75], v42, s[36:39], s58 offen sc1
  s_add_u32 s58, s86, 7168
  buffer_load_dwordx4 v[76:79], v42, s[36:39], s58 offen sc1
  s_waitcnt vmcnt(0)
  s_branch L_pollchk3
L_poll3:
  s_sub_u32 s81, s81, 1
  s_cmp_eq_u32 s81, 0
  s_cbranch_scc1 L_abort
  s_add_u32 s58, s86, 0
  buffer_load_dwordx4 v[48:51], v42, s[36:39], s58 offen sc1
  s_add_u32 s58, s86, 1024
  buffer_load_dwordx4 v[52:55], v42, s[36:39], s58 offen sc1
  s_add_u32 s58, s86, 2048
  buffer_load_dwordx4 v[56:59], v42, s[36:39], s58 offen sc1
  s_add_u32 s58, s86, 3072
  buffer_load_dwordx4 v[60:63], v42, s[36:39], s58 offen sc1
  s_add_u32 s58, s86, 4096
  buffer_load_dwordx4 v[64:67], v42, s[36:39], s58 offen sc1
  s_add_u32 s58, s86, 5120
  buffer_load_dwordx4 v[68:71], v42, s[36:39], s58 offen sc1
  s_add_u32 s58, s86, 6144
  buffer_load_dwordx4 v[72:75], v42, s[36:39], s58 offen sc1
  s_add_u32 s58, s86, 7168
  buffer_load_dwordx4 v[76:79], v42, s[36:39], s58 offen sc1
  s_waitcnt vmcnt(0)
L_pollchk3:
  v_cmp_ne_u32 vcc, v51, v3
  s_mov_b64 s[84:85], vcc
  v_cmp_ne_u32 vcc, v55, v3
  s_or_b64 s[84:85], s[84:85], vcc
  v_cmp_ne_u32 vcc, v59, v3
  s_or_b64 s[84:85], s[84:85], vcc
  v_cmp_ne_u32 vcc, v63, v3
  s_or_b64 s[84:85], s[84:85], vcc
  v_cmp_ne_u32 vcc, v67, v3
  s_or_b64 s[84:85], s[84:85], vcc
  v_cmp_ne_u32 vcc, v71, v3
  s_or_b64 s[84:85], s[84:85], vcc
  v_cmp_ne_u32 vcc, v75, v3
  s_or_b64 s[84:85], s[84:85], vcc
  v_cmp_ne_u32 vcc, v79, v3
  s_or_b64 s[84:85], s[84:85], vcc
  s_cmp_lg_u64 s[84:85], 0
  s_nop 2
  s_cbranch_scc1 L_poll3
  v_pk_add_f32 v[48:49], v[48:49], v[52:53]
  v_add_f32 v50, v50, v54
  v_pk_add_f32 v[48:49], v[48:49], v[56:57]
  v_add_f32 v50, v50, v58
  v_pk_add_f32 v[48:49], v[48:49], v[60:61]
  v_add_f32 v50, v50, v62
  v_pk_add_f32 v[48:49], v[48:49], v[64:65]
  v_add_f32 v50, v50, v66
  v_pk_add_f32 v[48:49], v[48:49], v[68:69]
  v_add_f32 v50, v50, v70
  v_pk_add_f32 v[48:49], v[48:49], v[72:73]
  v_add_f32 v50, v50, v74
  v_pk_add_f32 v[48:49], v[48:49], v[76:77]
  v_add_f32 v50, v50, v78
  v_cvt_pk_bf16_f32 v48, v48, v49
  v_cvt_pk_bf16_f32 v50, v50, v50
  v_mul_u32_u24 v41, 6, v1
  ds_write_b16 v41, v48 offset:5504
  ds_write_b16_d16_hi v41, v48 offset:5506
  ds_write_b16 v41, v50 offset:5508
  s_waitcnt lgkmcnt(0)
  v_mov_b32 v41, 2
  ds_write_b32 v232, v41 offset:2080
  s_waitcnt lgkmcnt(0)
  s_add_u32 s86, s78, 16
  s_lshl_b32 s86, s86, 13
  s_add_u32 s86, s86, 4096
  s_mov_b32 s81, 524288
  s_add_u32 s58, s86, 0
  buffer_load_dwordx4 v[48:51], v42, s[36:39], s58 offen sc1
  s_add_u32 s58, s86, 1024
  buffer_load_dwordx4 v[52:55], v42, s[36:39], s58 offen sc1
  s_add_u32 s58, s86, 2048
  buffer_load_dwordx4 v[56:59], v42, s[36:39], s58 offen sc1
  s_add_u32 s58, s86, 3072
  buffer_load_dwordx4 v[60:63], v42, s[36:39], s58 offen sc1
  s_add_u32 s58, s86, 4096
  buffer_load_dwordx4 v[64:67], v42, s[36:39], s58 offen sc1
  s_add_u32 s58, s86, 5120
  buffer_load_dwordx4 v[68:71], v42, s[36:39], s58 offen sc1
  s_add_u32 s58, s86, 6144
  buffer_load_dwordx4 v[72:75], v42, s[36:39], s58 offen sc1
  s_add_u32 s58, s86, 7168
  buffer_load_dwordx4 v[76:79], v42, s[36:39], s58 offen sc1
  s_waitcnt vmcnt(0)
  s_branch L_pollchk4
L_poll4:
  s_sub_u32 s81, s81, 1
  s_cmp_eq_u32 s81, 0
  s_cbranch_scc1 L_abort
  s_add_u32 s58, s86, 0
  buffer_load_dwordx4 v[48:51], v42, s[36:39], s58 offen sc1
  s_add_u32 s58, s86, 1024
  buffer_load_dwordx4 v[52:55], v42, s[36:39], s58 offen sc1
  s_add_u32 s58, s86, 2048
  buffer_load_dwordx4 v[56:59], v42, s[36:39], s58 offen sc1
  s_add_u32 s58, s86, 3072
  buffer_load_dwordx4 v[60:63], v42, s[36:39], s58 offen sc1
  s_add_u32 s58, s86, 4096
  buffer_load_dwordx4 v[64:67], v42, s[36:39], s58 offen sc1
  s_add_u32 s58, s86, 5120
  buffer_load_dwordx4 v[68:71], v42, s[36:39], s58 offen sc1
  s_add_u32 s58, s86, 6144
  buffer_load_dwordx4 v[72:75], v42, s[36:39], s58 offen sc1
  s_add_u32 s58, s86, 7168
  buffer_load_dwordx4 v[76:79], v42, s[36:39], s58 offen sc1
  s_waitcnt vmcnt(0)
L_pollchk4:
  v_cmp_ne_u32 vcc, v51, v3
  s_mov_b64 s[84:85], vcc
  v_cmp_ne_u32 vcc, v55, v3
  s_or_b64 s[84:85], s[84:85], vcc
  v_cmp_ne_u32 vcc, v59, v3
  s_or_b64 s[84:85], s[84:85], vcc
  v_cmp_ne_u32 vcc, v63, v3
  s_or_b64 s[84:85], s[84:85], vcc
  v_cmp_ne_u32 vcc, v67, v3
  s_or_b64 s[84:85], s[84:85], vcc
  v_cmp_ne_u32 vcc, v71, v3
  s_or_b64 s[84:85], s[84:85], vcc
  v_cmp_ne_u32 vcc, v75, v3
  s_or_b64 s[84:85], s[84:85], vcc
  v_cmp_ne_u32 vcc, v79, v3
  s_or_b64 s[84:85], s[84:85], vcc
  s_cmp_lg_u64 s[84:85], 0
  s_nop 2
  s_cbranch_scc1 L_poll4
  v_pk_add_f32 v[48:49], v[48:49], v[52:53]
  v_add_f32 v50, v50, v54
  v_pk_add_f32 v[48:49], v[48:49], v[56:57]
  v_add_f32 v50, v50, v58
  v_pk_add_f32 v[48:49], v[48:49], v[60:61]
  v_add_f32 v50, v50, v62
  v_pk_add_f32 v[48:49], v[48:49], v[64:65]
  v_add_f32 v50, v50, v66
  v_pk_add_f32 v[48:49], v[48:49], v[68:69]
  v_add_f32 v50, v50, v70
  v_pk_add_f32 v[48:49], v[48:49], v[72:73]
  v_add_f32 v50, v50, v74
  v_pk_add_f32 v[48:49], v[48:49], v[76:77]
  v_add_f32 v50, v50, v78
  v_cvt_pk_bf16_f32 v48, v48, v49
  v_cvt_pk_bf16_f32 v50, v50, v50
  v_mul_u32_u24 v41, 6, v1
  ds_write_b16 v41, v48 offset:5888
  ds_write_b16_d16_hi v41, v48 offset:5890
  ds_write_b16 v41, v50 offset:5892
  s_waitcnt lgkmcnt(0)
  v_mov_b32 v41, 3
  ds_write_b32 v232, v41 offset:2080
  s_waitcnt lgkmcnt(0)
  s_add_u32 s86, s78, 24
  s_lshl_b32 s86, s86, 13
  s_add_u32 s86, s86, 4096
  s_mov_b32 s81, 524288
  s_add_u32 s58, s86, 0
  buffer_load_dwordx4 v[48:51], v42, s[36:39], s58 offen sc1
  s_add_u32 s58, s86, 1024
  buffer_load_dwordx4 v[52:55], v42, s[36:39], s58 offen sc1
  s_add_u32 s58, s86, 2048
  buffer_load_dwordx4 v[56:59], v42, s[36:39], s58 offen sc1
  s_add_u32 s58, s86, 3072
  buffer_load_dwordx4 v[60:63], v42, s[36:39], s58 offen sc1
  s_add_u32 s58, s86, 4096
  buffer_load_dwordx4 v[64:67], v42, s[36:39], s58 offen sc1
  s_add_u32 s58, s86, 5120
  buffer_load_dwordx4 v[68:71], v42, s[36:39], s58 offen sc1
  s_add_u32 s58, s86, 6144
  buffer_load_dwordx4 v[72:75], v42, s[36:39], s58 offen sc1
  s_add_u32 s58, s86, 7168
  buffer_load_dwordx4 v[76:79], v42, s[36:39], s58 offen sc1
  s_waitcnt vmcnt(0)
  s_branch L_pollchk5
L_poll5:
  s_sub_u32 s81, s81, 1
  s_cmp_eq_u32 s81, 0
  s_cbranch_scc1 L_abort
  s_add_u32 s58, s86, 0
  buffer_load_dwordx4 v[48:51], v42, s[36:39], s58 offen sc1
  s_add_u32 s58, s86, 1024
  buffer_load_dwordx4 v[52:55], v42, s[36:39], s58 offen sc1
  s_add_u32 s58, s86, 2048
  buffer_load_dwordx4 v[56:59], v42, s[36:39], s58 offen sc1
  s_add_u32 s58, s86, 3072
  buffer_load_dwordx4 v[60:63], v42, s[36:39], s58 offen sc1
  s_add_u32 s58, s86, 4096
  buffer_load_dwordx4 v[64:67], v42, s[36:39], s58 offen sc1
  s_add_u32 s58, s86, 5120
  buffer_load_dwordx4 v[68:71], v42, s[36:39], s58 offen sc1
  s_add_u32 s58, s86, 6144
  buffer_load_dwordx4 v[72:75], v42, s[36:39], s58 offen sc1
  s_add_u32 s58, s86, 7168
  buffer_load_dwordx4 v[76:79], v42, s[36:39], s58 offen sc1
  s_waitcnt vmcnt(0)
L_pollchk5:
  v_cmp_ne_u32 vcc, v51, v3
  s_mov_b64 s[84:85], vcc
  v_cmp_ne_u32 vcc, v55, v3
  s_or_b64 s[84:85], s[84:85], vcc
  v_cmp_ne_u32 vcc, v59, v3
  s_or_b64 s[84:85], s[84:85], vcc
  v_cmp_ne_u32 vcc, v63, v3
  s_or_b64 s[84:85], s[84:85], vcc
  v_cmp_ne_u32 vcc, v67, v3
  s_or_b64 s[84:85], s[84:85], vcc
  v_cmp_ne_u32 vcc, v71, v3
  s_or_b64 s[84:85], s[84:85], vcc
  v_cmp_ne_u32 vcc, v75, v3
  s_or_b64 s[84:85], s[84:85], vcc
  v_cmp_ne_u32 vcc, v79, v3
  s_or_b64 s[84:85], s[84:85], vcc
  s_cmp_lg_u64 s[84:85], 0
  s_nop 2
  s_cbranch_scc1 L_poll5
  v_pk_add_f32 v[48:49], v[48:49], v[52:53]
  v_add_f32 v50, v50, v54
  v_pk_add_f32 v[48:49], v[48:49], v[56:57]
  v_add_f32 v50, v50, v58
  v_pk_add_f32 v[48:49], v[48:49], v[60:61]
  v_add_f32 v50, v50, v62
  v_pk_add_f32 v[48:49], v[48:49], v[64:65]
  v_add_f32 v50, v50, v66
  v_pk_add_f32 v[48:49], v[48:49], v[68:69]
  v_add_f32 v50, v50, v70
  v_pk_add_f32 v[48:49], v[48:49], v[72:73]
  v_add_f32 v50, v50, v74
  v_pk_add_f32 v[48:49], v[48:49], v[76:77]
  v_add_f32 v50, v50, v78
  v_cvt_pk_bf16_f32 v48, v48, v49
  v_cvt_pk_bf16_f32 v50, v50, v50
  v_mul_u32_u24 v41, 6, v1
  ds_write_b16 v41, v48 offset:6272
  ds_write_b16_d16_hi v41, v48 offset:6274
  ds_write_b16 v41, v50 offset:6276
  s_waitcnt lgkmcnt(0)
  v_mov_b32 v41, 4
  ds_write_b32 v232, v41 offset:2080
  s_waitcnt lgkmcnt(0)
  s_and_b32 s57, s49, 0xffffff00
  v_mov_b32 v44, s57
  s_add_u32 s86, s87, 1839104
  v_lshlrev_b32 v45, 2, v1
  v_mov_b32 v46, 0x800
  v_cmp_gt_u32 vcc, 32, v1
  s_nop 1
  v_cndmask_b32 v45, v46, v45, vcc
  s_lshr_b32 s58, s2, 3
  s_lshl_b32 s58, s58, 2
  v_mov_b32 v46, s58
  s_mov_b32 s47, 1
  s_cmp_lt_u32 s2, 8
  s_cselect_b32 s44, 1, 0
  v_lshlrev_b32 v40, 8, v1
  v_min_u32 v40, 1792, v40
  s_and_b32 s59, s2, 7
  s_lshl_b32 s59, s59, 8
  v_mov_b32 v38, s59
  v_mov_b32 v39, 0x800
  s_mov_b32 s98, 0
  s_mov_b32 s81, 4194304
  s_mov_b32 s48, 0
  s_mov_b32 s52, 0x07060500
  s_mov_b32 s53, 0x07060501
  s_mov_b32 s54, 0x07060502
  s_mov_b32 s55, 0x07060503
  s_lshr_b32 s79, s2, 3
  v_mul_u32_u24 v42, 43691, v1
  v_lshrrev_b32 v42, 19, v42
  v_mul_u32_u24 v43, 12, v42
  v_sub_u32 v43, v1, v43
  v_mul_u32_u24 v42, 6144, v42
  v_lshlrev_b32 v43, 4, v43
  v_add_u32 v227, v42, v43
  v_lshlrev_b32 v226, 4, v1
  s_nop 1
L_cspin:
  s_sleep 4
  ds_read_b32 v41, v232 offset:2048
  ds_read_b128 v[8:11], v232 offset:2064
  s_waitcnt lgkmcnt(0)
  v_readfirstlane_b32 s57, v41
  s_sub_u32 s81, s81, 1
  s_cmp_eq_u32 s81, 0
  s_nop 2
  s_cbranch_scc1 L_cdone
  v_min_u32 v8, v8, v9
  v_min_u32 v10, v10, v11
  v_min_u32 v8, v8, v10
  s_nop 0
  v_readfirstlane_b32 s58, v8
  s_cmp_gt_u32 s58, s48
  s_nop 3
  s_cbranch_scc0 L_cnopub
  s_mov_b32 exec_lo, 0xffffffff
  s_mov_b32 exec_hi, 0x0000ffff
  ds_read_b128 v[48:51], v226 offset:41984
  ds_read_b128 v[52:55], v226 offset:42752
  ds_read_b128 v[56:59], v226 offset:43520
  ds_read_b128 v[60:63], v226 offset:44288
  ds_read_b128 v[64:67], v226 offset:45056
  ds_read_b128 v[68:71], v226 offset:45824
  ds_read_b128 v[72:75], v226 offset:46592
  ds_read_b128 v[76:79], v226 offset:47360
  s_waitcnt lgkmcnt(0)
  s_add_u32 s58, s48, 1
  v_mov_b32 v42, s58
  ds_write_b32 v232, v42 offset:2060
  v_pk_add_f32 v[48:49], v[48:49], v[52:53]
  v_pk_add_f32 v[50:51], v[50:51], v[54:55]
  v_pk_add_f32 v[48:49], v[48:49], v[56:57]
  v_pk_add_f32 v[50:51], v[50:51], v[58:59]
  v_pk_add_f32 v[48:49], v[48:49], v[60:61]
  v_pk_add_f32 v[50:51], v[50:51], v[62:63]
  v_pk_add_f32 v[48:49], v[48:49], v[64:65]
  v_pk_add_f32 v[50:51], v[50:51], v[66:67]
  v_pk_add_f32 v[48:49], v[48:49], v[68:69]
  v_pk_add_f32 v[50:51], v[50:51], v[70:71]
  v_pk_add_f32 v[48:49], v[48:49], v[72:73]
  v_pk_add_f32 v[50:51], v[50:51], v[74:75]
  v_pk_add_f32 v[48:49], v[48:49], v[76:77]
  v_pk_add_f32 v[50:51], v[50:51], v[78:79]
  v_perm_b32 v48, v48, v3, s52
  v_perm_b32 v49, v49, v3, s53
  v_perm_b32 v50, v50, v3, s54
  v_perm_b32 v51, v51, v3, s55
  s_mul_i32 s59, s48, 8
  s_add_u32 s59, s59, s78
  s_mul_i32 s59, s59, 24576
  s_mul_i32 s60, s79, 192
  s_add_u32 s59, s59, s60
  s_add_u32 s59, s59, 393216
  s_cmp_eq_u32 s30, 1
  s_cbranch_scc1 L_pl6
  buffer_store_dwordx4 v[48:51], v227, s[36:39], s59 offen sc1
  s_nop 1
  s_branch L_pd6
L_pl6:
  buffer_store_dwordx4 v[48:51], v227, s[36:39], s59 offen
  s_nop 1
L_pd6:
  s_mov_b64 exec, -1
  s_mov_b32 s48, s58
L_cnopub:
  s_cmp_lg_u32 s57, s98
  s_cbranch_scc1 L_cchg
  s_branch L_cchk
L_cchg:
  s_mov_b32 s98, s57
  buffer_load_dword v42, v45, s[36:39], s86 offen sc1
  v_or_b32 v43, s98, v44
  s_mov_b64 exec, 1
  buffer_store_dword v43, v46, s[36:39], s86 offen
  s_mov_b64 exec, -1
  s_waitcnt vmcnt(1)
  v_xor_b32 v42, v42, v44
  s_mov_b32 s45, 16
  v_cmp_le_u32 vcc, s98, v42
  s_mov_b32 s59, vcc_lo
  v_cmp_gt_u32 vcc, 256, v42
  s_and_b32 s59, s59, vcc_lo
  s_bcnt1_i32_b32 s59, s59
  s_cmp_ge_u32 s59, s45
  s_cselect_b32 s59, 1, 0
  v_mov_b32 v41, s59
  ds_write_b32 v232, v41 offset:2052
  s_nop 0
L_cchk:
  s_cmp_lt_u32 s98, 30
  s_cbranch_scc1 L_cspin
  s_cmp_lt_u32 s48, 3
  s_cbranch_scc1 L_cspin
L_cdone:
  s_waitcnt vmcnt(0) lgkmcnt(0)
  s_endpgm
L_stream:
  v_mul_u32_u24 v2, 384, v43
  v_add_u32 v2, v2, v45
  s_and_b32 s78, s2, 7
  s_lshr_b32 s79, s2, 3
  s_lshl_b32 s47, s79, 2
  s_add_u32 s47, s47, s3
  s_mov_b32 s46, s78
  s_mov_b32 s48, 0
  s_mul_i32 s57, s46, 12582912
  s_mul_i32 s44, s47, 3072
  s_mov_b32 s34, 12582912
  s_mov_b32 s35, 0x20000
  s_waitcnt lgkmcnt(0)
  s_add_u32 s32, s6, s57
  s_addc_u32 s33, s7, 0
  buffer_load_dwordx4 v[108:111], v2, s[32:35], s44 offen offset:0 nt
  buffer_load_dwordx4 v[112:115], v2, s[32:35], s44 offen offset:128 nt
  buffer_load_dwordx4 v[116:119], v2, s[32:35], s44 offen offset:256 nt
  s_add_u32 s44, s44, 393216
  buffer_load_dwordx4 v[120:123], v2, s[32:35], s44 offen offset:0 nt
  buffer_load_dwordx4 v[124:127], v2, s[32:35], s44 offen offset:128 nt
  s_load_dword s49, s[28:29], 0
  v_mov_b32 v227, 0
  s_mov_b32 s87, 393216
  v_mov_b32 v4, 0
  v_mov_b32 v46, 0xffff
  v_cmp_eq_u32 vcc, 0, v44
  s_nop 1
  v_cndmask_b32 v4, v4, v46, vcc
  v_mov_b32 v46, 0xffff0000
  v_cmp_eq_u32 vcc, 1, v44
  s_nop 1
  v_cndmask_b32 v4, v4, v46, vcc
  v_mov_b32 v5, 0
  v_mov_b32 v46, 0xffff
  v_cmp_eq_u32 vcc, 2, v44
  s_nop 1
  v_cndmask_b32 v5, v5, v46, vcc
  v_mov_b32 v46, 0xffff0000
  v_cmp_eq_u32 vcc, 3, v44
  s_nop 1
  v_cndmask_b32 v5, v5, v46, vcc
  v_mov_b32 v6, 0
  v_mov_b32 v46, 0xffff
  v_cmp_eq_u32 vcc, 4, v44
  s_nop 1
  v_cndmask_b32 v6, v6, v46, vcc
  v_mov_b32 v46, 0xffff0000
  v_cmp_eq_u32 vcc, 5, v44
  s_nop 1
  v_cndmask_b32 v6, v6, v46, vcc
  v_mov_b32 v7, 0
  v_mov_b32 v46, 0xffff
  v_cmp_eq_u32 vcc, 6, v44
  s_nop 1
  v_cndmask_b32 v7, v7, v46, vcc
  v_mov_b32 v46, 0xffff0000
  v_cmp_eq_u32 vcc, 7, v44
  s_nop 1
  v_cndmask_b32 v7, v7, v46, vcc
  s_mov_b32 s48, 0
  s_mov_b32 s62, 0x01010101
  s_mov_b32 s63, 0x01010101
  s_mov_b32 s64, 0x02020202
  s_mov_b32 s65, 0x02020202
  s_mov_b32 s66, 0x04040404
  s_mov_b32 s67, 0x04040404
  s_mov_b32 s68, 0x08080808
  s_mov_b32 s69, 0x08080808
  s_mov_b32 s70, 0x10101010
  s_mov_b32 s71, 0x10101010
  s_mov_b32 s72, 0x20202020
  s_mov_b32 s73, 0x20202020
  s_mov_b32 s74, 0x40404040
  s_mov_b32 s75, 0x40404040
  s_mov_b32 s76, 0x80808080
  s_mov_b32 s77, 0x80808080
  s_mov_b32 s52, 0x07060500
  s_mov_b32 s53, 0x07060501
  s_mov_b32 s54, 0x07060502
  s_mov_b32 s55, 0x07060503
  s_mov_b32 s56, 0x0c0c0400
  s_mov_b32 s96, 0x07060302
  s_mov_b32 s90, 0xffff0000
  s_mov_b32 s91, 0x00000000
  s_mov_b32 s92, 0x00000000
  s_mov_b32 s93, 0x0000ffff
  s_mov_b32 s94, 0x00000000
  s_mov_b32 s95, 0xffff0000
  s_mov_b32 s36, s28
  s_mov_b32 s37, s29
  s_mov_b32 s38, 2097152
  s_mov_b32 s39, 0x20000
  s_and_b32 s57, s2, 7
  s_lshr_b32 s58, s2, 3
  s_lshl_b32 s59, s58, 3
  s_add_u32 s51, s59, s57
  s_mov_b32 s50, 0
  s_lshr_b32 s59, s58, 2
  s_lshl_b32 s59, s59, 3
  s_add_u32 s59, s59, s57
  s_lshl_b32 s59, s59, 2
  s_and_b32 s60, s58, 3
  s_add_u32 s99, s59, s60
  s_cmp_lt_u32 s58, 16
  s_cbranch_scc1 L_roled
  s_sub_u32 s59, s58, 16
  s_mul_i32 s60, s57, 12
  s_add_u32 s51, s60, s59
  s_mov_b32 s50, 1
  s_cmp_lt_u32 s58, 28
  s_cbranch_scc1 L_roled
  s_sub_u32 s59, s58, 28
  s_lshl_b32 s59, s59, 3
  s_add_u32 s51, s59, s57
  s_mov_b32 s50, 2
L_roled:
  v_mov_b32 v232, 0
  v_mov_b32 v233, 0
  s_mov_b32 s98, 0
  s_mov_b32 s97, 0
  s_barrier
  s_waitcnt vmcnt(4)
  buffer_load_dwordx4 v[128:131], v2, s[32:35], s44 offen offset:256 nt
  s_add_u32 s44, s44, 393216
  s_waitcnt vmcnt(4)
  buffer_load_dwordx4 v[132:135], v2, s[32:35], s44 offen offset:0 nt
  s_waitcnt vmcnt(4)
  buffer_load_dwordx4 v[136:139], v2, s[32:35], s44 offen offset:128 nt
  s_waitcnt vmcnt(4)
  buffer_load_dwordx4 v[140:143], v2, s[32:35], s44 offen offset:256 nt
  s_add_u32 s44, s44, 393216
  s_waitcnt vmcnt(4)
  buffer_load_dwordx4 v[48:51], v2, s[32:35], s44 offen offset:0 nt
  s_waitcnt vmcnt(4)
  buffer_load_dwordx4 v[52:55], v2, s[32:35], s44 offen offset:128 nt
  s_waitcnt vmcnt(4)
  buffer_load_dwordx4 v[56:59], v2, s[32:35], s44 offen offset:256 nt
  s_add_u32 s44, s44, 393216
  s_waitcnt vmcnt(4)
  buffer_load_dwordx4 v[60:63], v2, s[32:35], s44 offen offset:0 nt
  s_waitcnt vmcnt(4)
  buffer_load_dwordx4 v[64:67], v2, s[32:35], s44 offen offset:128 nt
  s_waitcnt vmcnt(4)
  buffer_load_dwordx4 v[68:71], v2, s[32:35], s44 offen offset:256 nt
  s_add_u32 s44, s44, 393216
  s_waitcnt vmcnt(4)
  buffer_load_dwordx4 v[72:75], v2, s[32:35], s44 offen offset:0 nt
  s_waitcnt vmcnt(4)
  buffer_load_dwordx4 v[76:79], v2, s[32:35], s44 offen offset:128 nt
  s_waitcnt vmcnt(4)
  buffer_load_dwordx4 v[80:83], v2, s[32:35], s44 offen offset:256 nt
  s_add_u32 s44, s44, 393216
  s_waitcnt vmcnt(4)
  buffer_load_dwordx4 v[84:87], v2, s[32:35], s44 offen offset:0 nt
  s_waitcnt vmcnt(4)
  buffer_load_dwordx4 v[88:91], v2, s[32:35], s44 offen offset:128 nt
  s_waitcnt vmcnt(4)
  buffer_load_dwordx4 v[92:95], v2, s[32:35], s44 offen offset:256 nt
  s_add_u32 s44, s44, 393216
  s_waitcnt vmcnt(4)
  buffer_load_dwordx4 v[96:99], v2, s[32:35], s44 offen offset:0 nt
  s_waitcnt vmcnt(4)
  buffer_load_dwordx4 v[100:103], v2, s[32:35], s44 offen offset:128 nt
  s_waitcnt vmcnt(4)
  buffer_load_dwordx4 v[104:107], v2, s[32:35], s44 offen offset:256 nt
  s_add_u32 s44, s44, 393216
  s_waitcnt vmcnt(4)
  buffer_load_dwordx4 v[144:147], v2, s[32:35], s44 offen offset:0 nt
  s_waitcnt vmcnt(4)
  buffer_load_dwordx4 v[148:151], v2, s[32:35], s44 offen offset:128 nt
  s_waitcnt vmcnt(4)
  buffer_load_dwordx4 v[152:155], v2, s[32:35], s44 offen offset:256 nt
  s_add_u32 s44, s44, 393216
  s_waitcnt vmcnt(4)
  buffer_load_dwordx4 v[156:159], v2, s[32:35], s44 offen offset:0 nt
  s_waitcnt vmcnt(4)
  buffer_load_dwordx4 v[160:163], v2, s[32:35], s44 offen offset:128 nt
  s_waitcnt vmcnt(4)
  buffer_load_dwordx4 v[164:167], v2, s[32:35], s44 offen offset:256 nt
  s_add_u32 s44, s44, 393216
  s_waitcnt vmcnt(4)
  buffer_load_dwordx4 v[168:171], v2, s[32:35], s44 offen offset:0 nt
  s_waitcnt vmcnt(4)
  buffer_load_dwordx4 v[172:175], v2, s[32:35], s44 offen offset:128 nt
  s_waitcnt vmcnt(4)
  buffer_load_dwordx4 v[176:179], v2, s[32:35], s44 offen offset:256 nt
  s_add_u32 s44, s44, 393216
  s_waitcnt vmcnt(4)
  buffer_load_dwordx4 v[180:183], v2, s[32:35], s44 offen offset:0 nt
  s_waitcnt vmcnt(4)
  buffer_load_dwordx4 v[184:187], v2, s[32:35], s44 offen offset:128 nt
  s_waitcnt vmcnt(4)
  buffer_load_dwordx4 v[188:191], v2, s[32:35], s44 offen offset:256 nt
  s_add_u32 s44, s44, 393216
  s_waitcnt vmcnt(4)
  buffer_load_dwordx4 v[192:195], v2, s[32:35], s44 offen offset:0 nt
  s_waitcnt vmcnt(4)
  buffer_load_dwordx4 v[196:199], v2, s[32:35], s44 offen offset:128 nt
  s_waitcnt vmcnt(4)
  buffer_load_dwordx4 v[200:203], v2, s[32:35], s44 offen offset:256 nt
  s_add_u32 s44, s44, 393216
  s_waitcnt vmcnt(4)
  buffer_load_dwordx4 v[204:207], v2, s[32:35], s44 offen offset:0 nt
  s_waitcnt vmcnt(4)
  buffer_load_dwordx4 v[208:211], v2, s[32:35], s44 offen offset:128 nt
  s_waitcnt vmcnt(4)
  buffer_load_dwordx4 v[212:215], v2, s[32:35], s44 offen offset:256 nt
  s_add_u32 s44, s44, 393216
  s_waitcnt vmcnt(4)
  buffer_load_dwordx4 v[24:27], v2, s[32:35], s44 offen offset:0 nt
  s_waitcnt vmcnt(4)
  buffer_load_dwordx4 v[28:31], v2, s[32:35], s44 offen offset:128 nt
  s_waitcnt vmcnt(4)
  buffer_load_dwordx4 v[32:35], v2, s[32:35], s44 offen offset:256 nt
  s_add_u32 s44, s44, 393216
  s_waitcnt lgkmcnt(0)
  s_add_u32 s49, s49, 0x9e3779b9
  v_mov_b32 v3, s49
  s_barrier
  ds_read_b32 v42, v232 offset:2056
  s_waitcnt lgkmcnt(0)
  v_readfirstlane_b32 s30, v42
  v_and_b32 v41, 7, v1
  v_lshlrev_b32 v41, 4, v41
  s_mul_i32 s57, s48, 384
  v_add_u32 v41, s57, v41
  ds_read_b128 v[12:15], v41 offset:5120
  ds_read_b128 v[16:19], v41 offset:5248
  ds_read_b128 v[20:23], v41 offset:5376
L_kcode:
  v_lshlrev_b32 v47, 2, v1
  s_lshl_b32 s57, s3, 12
  v_add_u32 v47, s57, v47
  v_mov_b32 v37, 0xff800000
  v_mov_b32 v224, 0
  s_waitcnt lgkmcnt(0)
  v_dot2_f32_bf16 v41, v108, v12, 0
  v_dot2_f32_bf16 v41, v109, v13, v41
  v_dot2_f32_bf16 v41, v110, v14, v41
  v_dot2_f32_bf16 v41, v111, v15, v41
  v_dot2_f32_bf16 v42, v112, v16, 0
  v_dot2_f32_bf16 v42, v113, v17, v42
  v_dot2_f32_bf16 v42, v114, v18, v42
  v_dot2_f32_bf16 v42, v115, v19, v42
  v_dot2_f32_bf16 v43, v116, v20, 0
  v_dot2_f32_bf16 v43, v117, v21, v43
  v_dot2_f32_bf16 v43, v118, v22, v43
  v_dot2_f32_bf16 v43, v119, v23, v43
  v_add_f32 v41, v41, v42
  s_nop 1
  v_add_f32 v41, v41, v43
  s_nop 1
  v_add_f32_dpp v41, v41, v41 quad_perm:[1,0,3,2] row_mask:0xf bank_mask:0xf
  s_nop 1
  v_add_f32_dpp v41, v41, v41 quad_perm:[2,3,0,1] row_mask:0xf bank_mask:0xf
  s_nop 1
  v_add_f32_dpp v41, v41, v41 row_half_mirror row_mask:0xf bank_mask:0xf
  v_cndmask_b32 v36, v36, v41, s[62:63]
  v_dot2_f32_bf16 v41, v120, v12, 0
  v_dot2_f32_bf16 v41, v121, v13, v41
  v_dot2_f32_bf16 v41, v122, v14, v41
  v_dot2_f32_bf16 v41, v123, v15, v41
  v_dot2_f32_bf16 v42, v124, v16, 0
  v_dot2_f32_bf16 v42, v125, v17, v42
  v_dot2_f32_bf16 v42, v126, v18, v42
  v_dot2_f32_bf16 v42, v127, v19, v42
  v_dot2_f32_bf16 v43, v128, v20, 0
  v_dot2_f32_bf16 v43, v129, v21, v43
  v_dot2_f32_bf16 v43, v130, v22, v43
  v_dot2_f32_bf16 v43, v131, v23, v43
  v_add_f32 v41, v41, v42
  s_nop 1
  v_add_f32 v41, v41, v43
  s_nop 1
  v_add_f32_dpp v41, v41, v41 quad_perm:[1,0,3,2] row_mask:0xf bank_mask:0xf
  s_nop 1
  v_add_f32_dpp v41, v41, v41 quad_perm:[2,3,0,1] row_mask:0xf bank_mask:0xf
  s_nop 1
  v_add_f32_dpp v41, v41, v41 row_half_mirror row_mask:0xf bank_mask:0xf
  v_cndmask_b32 v36, v36, v41, s[64:65]
  v_dot2_f32_bf16 v41, v132, v12, 0
  v_dot2_f32_bf16 v41, v133, v13, v41
  v_dot2_f32_bf16 v41, v134, v14, v41
  v_dot2_f32_bf16 v41, v135, v15, v41
  buffer_load_dwordx4 v[132:135], v2, s[32:35], s44 offen offset:0 nt
  v_dot2_f32_bf16 v42, v136, v16, 0
  v_dot2_f32_bf16 v42, v137, v17, v42
  v_dot2_f32_bf16 v42, v138, v18, v42
  v_dot2_f32_bf16 v42, v139, v19, v42
  buffer_load_dwordx4 v[136:139], v2, s[32:35], s44 offen offset:128 nt
  v_dot2_f32_bf16 v43, v140, v20, 0
  v_dot2_f32_bf16 v43, v141, v21, v43
  v_dot2_f32_bf16 v43, v142, v22, v43
  v_dot2_f32_bf16 v43, v143, v23, v43
  v_add_f32 v41, v41, v42
  s_nop 1
  v_add_f32 v41, v41, v43
  s_nop 1
  v_add_f32_dpp v41, v41, v41 quad_perm:[1,0,3,2] row_mask:0xf bank_mask:0xf
  s_nop 1
  v_add_f32_dpp v41, v41, v41 quad_perm:[2,3,0,1] row_mask:0xf bank_mask:0xf
  s_nop 1
  v_add_f32_dpp v41, v41, v41 row_half_mirror row_mask:0xf bank_mask:0xf
  v_cndmask_b32 v36, v36, v41, s[66:67]
  buffer_load_dwordx4 v[140:143], v2, s[32:35], s44 offen offset:256 nt
  s_add_u32 s44, s44, 393216
  v_dot2_f32_bf16 v41, v48, v12, 0
  v_dot2_f32_bf16 v41, v49, v13, v41
  v_dot2_f32_bf16 v41, v50, v14, v41
  v_dot2_f32_bf16 v41, v51, v15, v41
  buffer_load_dwordx4 v[48:51], v2, s[32:35], s44 offen offset:0 nt
  v_dot2_f32_bf16 v42, v52, v16, 0
  v_dot2_f32_bf16 v42, v53, v17, v42
  v_dot2_f32_bf16 v42, v54, v18, v42
  v_dot2_f32_bf16 v42, v55, v19, v42
  buffer_load_dwordx4 v[52:55], v2, s[32:35], s44 offen offset:128 nt
  v_dot2_f32_bf16 v43, v56, v20, 0
  v_dot2_f32_bf16 v43, v57, v21, v43
  v_dot2_f32_bf16 v43, v58, v22, v43
  v_dot2_f32_bf16 v43, v59, v23, v43
  v_add_f32 v41, v41, v42
  s_nop 1
  v_add_f32 v41, v41, v43
  s_nop 1
  v_add_f32_dpp v41, v41, v41 quad_perm:[1,0,3,2] row_mask:0xf bank_mask:0xf
  s_nop 1
  v_add_f32_dpp v41, v41, v41 quad_perm:[2,3,0,1] row_mask:0xf bank_mask:0xf
  s_nop 1
  v_add_f32_dpp v41, v41, v41 row_half_mirror row_mask:0xf bank_mask:0xf
  v_cndmask_b32 v36, v36, v41, s[68:69]
  v_dot2_f32_bf16 v41, v60, v12, 0
  v_dot2_f32_bf16 v41, v61, v13, v41
  v_dot2_f32_bf16 v41, v62, v14, v41
  v_dot2_f32_bf16 v41, v63, v15, v41
  v_dot2_f32_bf16 v42, v64, v16, 0
  v_dot2_f32_bf16 v42, v65, v17, v42
  v_dot2_f32_bf16 v42, v66, v18, v42
  v_dot2_f32_bf16 v42, v67, v19, v42
  v_dot2_f32_bf16 v43, v68, v20, 0
  v_dot2_f32_bf16 v43, v69, v21, v43
  v_dot2_f32_bf16 v43, v70, v22, v43
  v_dot2_f32_bf16 v43, v71, v23, v43
  v_add_f32 v41, v41, v42
  s_nop 1
  v_add_f32 v41, v41, v43
  s_nop 1
  v_add_f32_dpp v41, v41, v41 quad_perm:[1,0,3,2] row_mask:0xf bank_mask:0xf
  s_nop 1
  v_add_f32_dpp v41, v41, v41 quad_perm:[2,3,0,1] row_mask:0xf bank_mask:0xf
  s_nop 1
  v_add_f32_dpp v41, v41, v41 row_half_mirror row_mask:0xf bank_mask:0xf
  v_cndmask_b32 v36, v36, v41, s[70:71]
  v_dot2_f32_bf16 v41, v72, v12, 0
  v_dot2_f32_bf16 v41, v73, v13, v41
  v_dot2_f32_bf16 v41, v74, v14, v41
  v_dot2_f32_bf16 v41, v75, v15, v41
  v_dot2_f32_bf16 v42, v76, v16, 0
  v_dot2_f32_bf16 v42, v77, v17, v42
  v_dot2_f32_bf16 v42, v78, v18, v42
  v_dot2_f32_bf16 v42, v79, v19, v42
  v_dot2_f32_bf16 v43, v80, v20, 0
  v_dot2_f32_bf16 v43, v81, v21, v43
  v_dot2_f32_bf16 v43, v82, v22, v43
  v_dot2_f32_bf16 v43, v83, v23, v43
  v_add_f32 v41, v41, v42
  s_nop 1
  v_add_f32 v41, v41, v43
  s_nop 1
  v_add_f32_dpp v41, v41, v41 quad_perm:[1,0,3,2] row_mask:0xf bank_mask:0xf
  s_nop 1
  v_add_f32_dpp v41, v41, v41 quad_perm:[2,3,0,1] row_mask:0xf bank_mask:0xf
  s_nop 1
  v_add_f32_dpp v41, v41, v41 row_half_mirror row_mask:0xf bank_mask:0xf
  v_cndmask_b32 v36, v36, v41, s[72:73]
  v_dot2_f32_bf16 v41, v84, v12, 0
  v_dot2_f32_bf16 v41, v85, v13, v41
  v_dot2_f32_bf16 v41, v86, v14, v41
  v_dot2_f32_bf16 v41, v87, v15, v41
  v_dot2_f32_bf16 v42, v88, v16, 0
  v_dot2_f32_bf16 v42, v89, v17, v42
  v_dot2_f32_bf16 v42, v90, v18, v42
  v_dot2_f32_bf16 v42, v91, v19, v42
  v_dot2_f32_bf16 v43, v92, v20, 0
  v_dot2_f32_bf16 v43, v93, v21, v43
  v_dot2_f32_bf16 v43, v94, v22, v43
  v_dot2_f32_bf16 v43, v95, v23, v43
  v_add_f32 v41, v41, v42
  s_nop 1
  v_add_f32 v41, v41, v43
  s_nop 1
  v_add_f32_dpp v41, v41, v41 quad_perm:[1,0,3,2] row_mask:0xf bank_mask:0xf
  s_nop 1
  v_add_f32_dpp v41, v41, v41 quad_perm:[2,3,0,1] row_mask:0xf bank_mask:0xf
  s_nop 1
  v_add_f32_dpp v41, v41, v41 row_half_mirror row_mask:0xf bank_mask:0xf
  v_cndmask_b32 v36, v36, v41, s[74:75]
  v_dot2_f32_bf16 v41, v96, v12, 0
  v_dot2_f32_bf16 v41, v97, v13, v41
  v_dot2_f32_bf16 v41, v98, v14, v41
  v_dot2_f32_bf16 v41, v99, v15, v41
  v_dot2_f32_bf16 v42, v100, v16, 0
  v_dot2_f32_bf16 v42, v101, v17, v42
  v_dot2_f32_bf16 v42, v102, v18, v42
  v_dot2_f32_bf16 v42, v103, v19, v42
  v_dot2_f32_bf16 v43, v104, v20, 0
  v_dot2_f32_bf16 v43, v105, v21, v43
  v_dot2_f32_bf16 v43, v106, v22, v43
  v_dot2_f32_bf16 v43, v107, v23, v43
  v_add_f32 v41, v41, v42
  s_nop 1
  v_add_f32 v41, v41, v43
  s_nop 1
  v_add_f32_dpp v41, v41, v41 quad_perm:[1,0,3,2] row_mask:0xf bank_mask:0xf
  s_nop 1
  v_add_f32_dpp v41, v41, v41 quad_perm:[2,3,0,1] row_mask:0xf bank_mask:0xf
  s_nop 1
  v_add_f32_dpp v41, v41, v41 row_half_mirror row_mask:0xf bank_mask:0xf
  v_cndmask_b32 v36, v36, v41, s[76:77]
  v_cvt_pk_bf16_f32 v41, v36, v36
  v_lshlrev_b32 v41, 16, v41
  v_mul_f32 v41, 0x3d93cd3a, v41
  v_cvt_pk_bf16_f32 v41, v41, v41
  v_lshlrev_b32 v41, 16, v41
  ds_write_b32 v47, v41 offset:25088
  v_add_u32 v47, 256, v47
  v_max_f32 v42, v37, v41
  v_sub_f32 v43, v37, v42
  v_sub_f32 v41, v41, v42
  v_mul_f32 v43, 0x3fb8aa3b, v43
  v_mul_f32 v41, 0x3fb8aa3b, v41
  v_exp_f32 v43, v43
  v_exp_f32 v41, v41
  v_mov_b32 v37, v42
  v_fma_f32 v224, v224, v43, v41
  s_add_u32 s98, s98, 1
  s_cmp_lg_u32 s3, 0
  s_cbranch_scc1 L_pg7
  v_mov_b32 v46, s98
  ds_write_b32 v232, v46 offset:2048
  s_nop 0
L_pg7:
  v_dot2_f32_bf16 v41, v144, v12, 0
  v_dot2_f32_bf16 v41, v145, v13, v41
  v_dot2_f32_bf16 v41, v146, v14, v41
  v_dot2_f32_bf16 v41, v147, v15, v41
  v_dot2_f32_bf16 v42, v148, v16, 0
  v_dot2_f32_bf16 v42, v149, v17, v42
  v_dot2_f32_bf16 v42, v150, v18, v42
  v_dot2_f32_bf16 v42, v151, v19, v42
  v_dot2_f32_bf16 v43, v152, v20, 0
  v_dot2_f32_bf16 v43, v153, v21, v43
  v_dot2_f32_bf16 v43, v154, v22, v43
  v_dot2_f32_bf16 v43, v155, v23, v43
  v_add_f32 v41, v41, v42
  s_nop 1
  v_add_f32 v41, v41, v43
  s_nop 1
  v_add_f32_dpp v41, v41, v41 quad_perm:[1,0,3,2] row_mask:0xf bank_mask:0xf
  s_nop 1
  v_add_f32_dpp v41, v41, v41 quad_perm:[2,3,0,1] row_mask:0xf bank_mask:0xf
  s_nop 1
  v_add_f32_dpp v41, v41, v41 row_half_mirror row_mask:0xf bank_mask:0xf
  v_cndmask_b32 v36, v36, v41, s[62:63]
  v_dot2_f32_bf16 v41, v156, v12, 0
  v_dot2_f32_bf16 v41, v157, v13, v41
  v_dot2_f32_bf16 v41, v158, v14, v41
  v_dot2_f32_bf16 v41, v159, v15, v41
  v_dot2_f32_bf16 v42, v160, v16, 0
  v_dot2_f32_bf16 v42, v161, v17, v42
  v_dot2_f32_bf16 v42, v162, v18, v42
  v_dot2_f32_bf16 v42, v163, v19, v42
  v_dot2_f32_bf16 v43, v164, v20, 0
  v_dot2_f32_bf16 v43, v165, v21, v43
  v_dot2_f32_bf16 v43, v166, v22, v43
  v_dot2_f32_bf16 v43, v167, v23, v43
  v_add_f32 v41, v41, v42
  s_nop 1
  v_add_f32 v41, v41, v43
  s_nop 1
  v_add_f32_dpp v41, v41, v41 quad_perm:[1,0,3,2] row_mask:0xf bank_mask:0xf
  s_nop 1
  v_add_f32_dpp v41, v41, v41 quad_perm:[2,3,0,1] row_mask:0xf bank_mask:0xf
  s_nop 1
  v_add_f32_dpp v41, v41, v41 row_half_mirror row_mask:0xf bank_mask:0xf
  v_cndmask_b32 v36, v36, v41, s[64:65]
  v_dot2_f32_bf16 v41, v168, v12, 0
  v_dot2_f32_bf16 v41, v169, v13, v41
  v_dot2_f32_bf16 v41, v170, v14, v41
  v_dot2_f32_bf16 v41, v171, v15, v41
  v_dot2_f32_bf16 v42, v172, v16, 0
  v_dot2_f32_bf16 v42, v173, v17, v42
  v_dot2_f32_bf16 v42, v174, v18, v42
  v_dot2_f32_bf16 v42, v175, v19, v42
  v_dot2_f32_bf16 v43, v176, v20, 0
  v_dot2_f32_bf16 v43, v177, v21, v43
  v_dot2_f32_bf16 v43, v178, v22, v43
  v_dot2_f32_bf16 v43, v179, v23, v43
  v_add_f32 v41, v41, v42
  s_nop 1
  v_add_f32 v41, v41, v43
  s_nop 1
  v_add_f32_dpp v41, v41, v41 quad_perm:[1,0,3,2] row_mask:0xf bank_mask:0xf
  s_nop 1
  v_add_f32_dpp v41, v41, v41 quad_perm:[2,3,0,1] row_mask:0xf bank_mask:0xf
  s_nop 1
  v_add_f32_dpp v41, v41, v41 row_half_mirror row_mask:0xf bank_mask:0xf
  v_cndmask_b32 v36, v36, v41, s[66:67]
  v_dot2_f32_bf16 v41, v180, v12, 0
  v_dot2_f32_bf16 v41, v181, v13, v41
  v_dot2_f32_bf16 v41, v182, v14, v41
  v_dot2_f32_bf16 v41, v183, v15, v41
  v_dot2_f32_bf16 v42, v184, v16, 0
  v_dot2_f32_bf16 v42, v185, v17, v42
  v_dot2_f32_bf16 v42, v186, v18, v42
  v_dot2_f32_bf16 v42, v187, v19, v42
  v_dot2_f32_bf16 v43, v188, v20, 0
  v_dot2_f32_bf16 v43, v189, v21, v43
  v_dot2_f32_bf16 v43, v190, v22, v43
  v_dot2_f32_bf16 v43, v191, v23, v43
  v_add_f32 v41, v41, v42
  s_nop 1
  v_add_f32 v41, v41, v43
  s_nop 1
  v_add_f32_dpp v41, v41, v41 quad_perm:[1,0,3,2] row_mask:0xf bank_mask:0xf
  s_nop 1
  v_add_f32_dpp v41, v41, v41 quad_perm:[2,3,0,1] row_mask:0xf bank_mask:0xf
  s_nop 1
  v_add_f32_dpp v41, v41, v41 row_half_mirror row_mask:0xf bank_mask:0xf
  v_cndmask_b32 v36, v36, v41, s[68:69]
  v_dot2_f32_bf16 v41, v192, v12, 0
  v_dot2_f32_bf16 v41, v193, v13, v41
  v_dot2_f32_bf16 v41, v194, v14, v41
  v_dot2_f32_bf16 v41, v195, v15, v41
  v_dot2_f32_bf16 v42, v196, v16, 0
  v_dot2_f32_bf16 v42, v197, v17, v42
  v_dot2_f32_bf16 v42, v198, v18, v42
  v_dot2_f32_bf16 v42, v199, v19, v42
  v_dot2_f32_bf16 v43, v200, v20, 0
  v_dot2_f32_bf16 v43, v201, v21, v43
  v_dot2_f32_bf16 v43, v202, v22, v43
  v_dot2_f32_bf16 v43, v203, v23, v43
  v_add_f32 v41, v41, v42
  s_nop 1
  v_add_f32 v41, v41, v43
  s_nop 1
  v_add_f32_dpp v41, v41, v41 quad_perm:[1,0,3,2] row_mask:0xf bank_mask:0xf
  s_nop 1
  v_add_f32_dpp v41, v41, v41 quad_perm:[2,3,0,1] row_mask:0xf bank_mask:0xf
  s_nop 1
  v_add_f32_dpp v41, v41, v41 row_half_mirror row_mask:0xf bank_mask:0xf
  v_cndmask_b32 v36, v36, v41, s[70:71]
  v_dot2_f32_bf16 v41, v204, v12, 0
  v_dot2_f32_bf16 v41, v205, v13, v41
  v_dot2_f32_bf16 v41, v206, v14, v41
  v_dot2_f32_bf16 v41, v207, v15, v41
  s_waitcnt vmcnt(9)
  v_dot2_f32_bf16 v42, v208, v16, 0
  v_dot2_f32_bf16 v42, v209, v17, v42
  v_dot2_f32_bf16 v42, v210, v18, v42
  v_dot2_f32_bf16 v42, v211, v19, v42
  s_waitcnt vmcnt(8)
  v_dot2_f32_bf16 v43, v212, v20, 0
  v_dot2_f32_bf16 v43, v213, v21, v43
  v_dot2_f32_bf16 v43, v214, v22, v43
  v_dot2_f32_bf16 v43, v215, v23, v43
  v_add_f32 v41, v41, v42
  s_nop 1
  v_add_f32 v41, v41, v43
  s_nop 1
  v_add_f32_dpp v41, v41, v41 quad_perm:[1,0,3,2] row_mask:0xf bank_mask:0xf
  s_nop 1
  v_add_f32_dpp v41, v41, v41 quad_perm:[2,3,0,1] row_mask:0xf bank_mask:0xf
  s_nop 1
  v_add_f32_dpp v41, v41, v41 row_half_mirror row_mask:0xf bank_mask:0xf
  v_cndmask_b32 v36, v36, v41, s[72:73]
  s_waitcnt vmcnt(7)
  v_dot2_f32_bf16 v41, v24, v12, 0
  v_dot2_f32_bf16 v41, v25, v13, v41
  v_dot2_f32_bf16 v41, v26, v14, v41
  v_dot2_f32_bf16 v41, v27, v15, v41
  s_waitcnt vmcnt(6)
  v_dot2_f32_bf16 v42, v28, v16, 0
  v_dot2_f32_bf16 v42, v29, v17, v42
  v_dot2_f32_bf16 v42, v30, v18, v42
  v_dot2_f32_bf16 v42, v31, v19, v42
  s_waitcnt vmcnt(5)
  v_dot2_f32_bf16 v43, v32, v20, 0
  v_dot2_f32_bf16 v43, v33, v21, v43
  v_dot2_f32_bf16 v43, v34, v22, v43
  v_dot2_f32_bf16 v43, v35, v23, v43
  v_add_f32 v41, v41, v42
  s_nop 1
  v_add_f32 v41, v41, v43
  s_nop 1
  v_add_f32_dpp v41, v41, v41 quad_perm:[1,0,3,2] row_mask:0xf bank_mask:0xf
  s_nop 1
  v_add_f32_dpp v41, v41, v41 quad_perm:[2,3,0,1] row_mask:0xf bank_mask:0xf
  s_nop 1
  v_add_f32_dpp v41, v41, v41 row_half_mirror row_mask:0xf bank_mask:0xf
  v_cndmask_b32 v36, v36, v41, s[74:75]
  s_waitcnt vmcnt(4)
  buffer_load_dwordx4 v[56:59], v2, s[32:35], s44 offen offset:256 nt
  s_add_u32 s44, s44, 393216
  v_dot2_f32_bf16 v41, v132, v12, 0
  v_dot2_f32_bf16 v41, v133, v13, v41
  v_dot2_f32_bf16 v41, v134, v14, v41
  v_dot2_f32_bf16 v41, v135, v15, v41
  s_waitcnt vmcnt(4)
  buffer_load_dwordx4 v[60:63], v2, s[32:35], s44 offen offset:0 nt
  v_dot2_f32_bf16 v42, v136, v16, 0
  v_dot2_f32_bf16 v42, v137, v17, v42
  v_dot2_f32_bf16 v42, v138, v18, v42
  v_dot2_f32_bf16 v42, v139, v19, v42
  s_waitcnt vmcnt(4)
  buffer_load_dwordx4 v[64:67], v2, s[32:35], s44 offen offset:128 nt
  v_dot2_f32_bf16 v43, v140, v20, 0
  v_dot2_f32_bf16 v43, v141, v21, v43
  v_dot2_f32_bf16 v43, v142, v22, v43
  v_dot2_f32_bf16 v43, v143, v23, v43
  v_add_f32 v41, v41, v42
  s_nop 1
  v_add_f32 v41, v41, v43
  s_nop 1
  v_add_f32_dpp v41, v41, v41 quad_perm:[1,0,3,2] row_mask:0xf bank_mask:0xf
  s_nop 1
  v_add_f32_dpp v41, v41, v41 quad_perm:[2,3,0,1] row_mask:0xf bank_mask:0xf
  s_nop 1
  v_add_f32_dpp v41, v41, v41 row_half_mirror row_mask:0xf bank_mask:0xf
  v_cndmask_b32 v36, v36, v41, s[76:77]
  v_cvt_pk_bf16_f32 v41, v36, v36
  v_lshlrev_b32 v41, 16, v41
  v_mul_f32 v41, 0x3d93cd3a, v41
  v_cvt_pk_bf16_f32 v41, v41, v41
  v_lshlrev_b32 v41, 16, v41
  ds_write_b32 v47, v41 offset:25088
  v_add_u32 v47, 256, v47
  v_max_f32 v42, v37, v41
  v_sub_f32 v43, v37, v42
  v_sub_f32 v41, v41, v42
  v_mul_f32 v43, 0x3fb8aa3b, v43
  v_mul_f32 v41, 0x3fb8aa3b, v41
  v_exp_f32 v43, v43
  v_exp_f32 v41, v41
  v_mov_b32 v37, v42
  v_fma_f32 v224, v224, v43, v41
  s_add_u32 s98, s98, 1
  s_cmp_lg_u32 s3, 0
  s_cbranch_scc1 L_pg8
  v_mov_b32 v46, s98
  ds_write_b32 v232, v46 offset:2048
  s_nop 0
L_pg8:
  ds_read_b32 v233, v232 offset:2052
  s_mov_b32 s45, 2
L_kloop:
  s_waitcnt lgkmcnt(0)
  v_readfirstlane_b32 s31, v233
  s_cmp_eq_u32 s31, 1
  s_nop 3
  s_cbranch_scc1 L_kboost
  s_cmp_eq_u32 s97, 0
  s_cbranch_scc1 L_kn0
  s_waitcnt vmcnt(6)
  v_dot2_f32_bf16 v41, v48, v12, 0
  v_dot2_f32_bf16 v41, v49, v13, v41
  v_dot2_f32_bf16 v41, v50, v14, v41
  v_dot2_f32_bf16 v41, v51, v15, v41
  s_waitcnt vmcnt(5)
  v_dot2_f32_bf16 v42, v52, v16, 0
  v_dot2_f32_bf16 v42, v53, v17, v42
  v_dot2_f32_bf16 v42, v54, v18, v42
  v_dot2_f32_bf16 v42, v55, v19, v42
  s_nop 2
  s_branch L_kn1
L_kn0:
  s_waitcnt vmcnt(4)
  buffer_load_dwordx4 v[68:71], v2, s[32:35], s44 offen offset:256 nt
  s_add_u32 s44, s44, 393216
  v_dot2_f32_bf16 v41, v48, v12, 0
  v_dot2_f32_bf16 v41, v49, v13, v41
  v_dot2_f32_bf16 v41, v50, v14, v41
  v_dot2_f32_bf16 v41, v51, v15, v41
  s_waitcnt vmcnt(4)
  buffer_load_dwordx4 v[72:75], v2, s[32:35], s44 offen offset:0 nt
  v_dot2_f32_bf16 v42, v52, v16, 0
  v_dot2_f32_bf16 v42, v53, v17, v42
  v_dot2_f32_bf16 v42, v54, v18, v42
  v_dot2_f32_bf16 v42, v55, v19, v42
  s_nop 2
L_kn1:
  s_waitcnt vmcnt(4)
  buffer_load_dwordx4 v[76:79], v2, s[32:35], s44 offen offset:128 nt
  v_dot2_f32_bf16 v43, v56, v20, 0
  v_dot2_f32_bf16 v43, v57, v21, v43
  v_dot2_f32_bf16 v43, v58, v22, v43
  v_dot2_f32_bf16 v43, v59, v23, v43
  v_add_f32 v41, v41, v42
  s_nop 1
  v_add_f32 v41, v41, v43
  s_nop 1
  v_add_f32_dpp v41, v41, v41 quad_perm:[1,0,3,2] row_mask:0xf bank_mask:0xf
  s_nop 1
  v_add_f32_dpp v41, v41, v41 quad_perm:[2,3,0,1] row_mask:0xf bank_mask:0xf
  s_nop 1
  v_add_f32_dpp v41, v41, v41 row_half_mirror row_mask:0xf bank_mask:0xf
  v_cndmask_b32 v36, v36, v41, s[62:63]
  s_waitcnt vmcnt(4)
  buffer_load_dwordx4 v[80:83], v2, s[32:35], s44 offen offset:256 nt
  s_add_u32 s44, s44, 393216
  v_dot2_f32_bf16 v41, v60, v12, 0
  v_dot2_f32_bf16 v41, v61, v13, v41
  v_dot2_f32_bf16 v41, v62, v14, v41
  v_dot2_f32_bf16 v41, v63, v15, v41
  s_waitcnt vmcnt(4)
  buffer_load_dwordx4 v[84:87], v2, s[32:35], s44 offen offset:0 nt
  v_dot2_f32_bf16 v42, v64, v16, 0
  v_dot2_f32_bf16 v42, v65, v17, v42
  v_dot2_f32_bf16 v42, v66, v18, v42
  v_dot2_f32_bf16 v42, v67, v19, v42
  s_waitcnt vmcnt(4)
  buffer_load_dwordx4 v[88:91], v2, s[32:35], s44 offen offset:128 nt
  v_dot2_f32_bf16 v43, v68, v20, 0
  v_dot2_f32_bf16 v43, v69, v21, v43
  v_dot2_f32_bf16 v43, v70, v22, v43
  v_dot2_f32_bf16 v43, v71, v23, v43
  v_add_f32 v41, v41, v42
  s_nop 1
  v_add_f32 v41, v41, v43
  s_nop 1
  v_add_f32_dpp v41, v41, v41 quad_perm:[1,0,3,2] row_mask:0xf bank_mask:0xf
  s_nop 1
  v_add_f32_dpp v41, v41, v41 quad_perm:[2,3,0,1] row_mask:0xf bank_mask:0xf
  s_nop 1
  v_add_f32_dpp v41, v41, v41 row_half_mirror row_mask:0xf bank_mask:0xf
  v_cndmask_b32 v36, v36, v41, s[64:65]
  s_waitcnt vmcnt(4)
  buffer_load_dwordx4 v[92:95], v2, s[32:35], s44 offen offset:256 nt
  s_add_u32 s44, s44, 393216
  v_dot2_f32_bf16 v41, v72, v12, 0
  v_dot2_f32_bf16 v41, v73, v13, v41
  v_dot2_f32_bf16 v41, v74, v14, v41
  v_dot2_f32_bf16 v41, v75, v15, v41
  s_waitcnt vmcnt(4)
  buffer_load_dwordx4 v[96:99], v2, s[32:35], s44 offen offset:0 nt
  v_dot2_f32_bf16 v42, v76, v16, 0
  v_dot2_f32_bf16 v42, v77, v17, v42
  v_dot2_f32_bf16 v42, v78, v18, v42
  v_dot2_f32_bf16 v42, v79, v19, v42
  s_waitcnt vmcnt(4)
  buffer_load_dwordx4 v[100:103], v2, s[32:35], s44 offen offset:128 nt
  v_dot2_f32_bf16 v43, v80, v20, 0
  v_dot2_f32_bf16 v43, v81, v21, v43
  v_dot2_f32_bf16 v43, v82, v22, v43
  v_dot2_f32_bf16 v43, v83, v23, v43
  v_add_f32 v41, v41, v42
  s_nop 1
  v_add_f32 v41, v41, v43
  s_nop 1
  v_add_f32_dpp v41, v41, v41 quad_perm:[1,0,3,2] row_mask:0xf bank_mask:0xf
  s_nop 1
  v_add_f32_dpp v41, v41, v41 quad_perm:[2,3,0,1] row_mask:0xf bank_mask:0xf
  s_nop 1
  v_add_f32_dpp v41, v41, v41 row_half_mirror row_mask:0xf bank_mask:0xf
  v_cndmask_b32 v36, v36, v41, s[66:67]
  s_waitcnt vmcnt(4)
  buffer_load_dwordx4 v[104:107], v2, s[32:35], s44 offen offset:256 nt
  s_add_u32 s44, s44, 393216
  v_dot2_f32_bf16 v41, v84, v12, 0
  v_dot2_f32_bf16 v41, v85, v13, v41
  v_dot2_f32_bf16 v41, v86, v14, v41
  v_dot2_f32_bf16 v41, v87, v15, v41
  s_waitcnt vmcnt(4)
  buffer_load_dwordx4 v[108:111], v2, s[32:35], s44 offen offset:0 nt
  v_dot2_f32_bf16 v42, v88, v16, 0
  v_dot2_f32_bf16 v42, v89, v17, v42
  v_dot2_f32_bf16 v42, v90, v18, v42
  v_dot2_f32_bf16 v42, v91, v19, v42
  s_waitcnt vmcnt(4)
  buffer_load_dwordx4 v[112:115], v2, s[32:35], s44 offen offset:128 nt
  v_dot2_f32_bf16 v43, v92, v20, 0
  v_dot2_f32_bf16 v43, v93, v21, v43
  v_dot2_f32_bf16 v43, v94, v22, v43
  v_dot2_f32_bf16 v43, v95, v23, v43
  v_add_f32 v41, v41, v42
  s_nop 1
  v_add_f32 v41, v41, v43
  s_nop 1
  v_add_f32_dpp v41, v41, v41 quad_perm:[1,0,3,2] row_mask:0xf bank_mask:0xf
  s_nop 1
  v_add_f32_dpp v41, v41, v41 quad_perm:[2,3,0,1] row_mask:0xf bank_mask:0xf
  s_nop 1
  v_add_f32_dpp v41, v41, v41 row_half_mirror row_mask:0xf bank_mask:0xf
  v_cndmask_b32 v36, v36, v41, s[68:69]
  s_waitcnt vmcnt(4)
  buffer_load_dwordx4 v[116:119], v2, s[32:35], s44 offen offset:256 nt
  s_add_u32 s44, s44, 393216
  ds_read_b32 v233, v232 offset:2052
  v_dot2_f32_bf16 v41, v96, v12, 0
  v_dot2_f32_bf16 v41, v97, v13, v41
  v_dot2_f32_bf16 v41, v98, v14, v41
  v_dot2_f32_bf16 v41, v99, v15, v41
  s_waitcnt vmcnt(4)
  buffer_load_dwordx4 v[120:123], v2, s[32:35], s44 offen offset:0 nt
  v_dot2_f32_bf16 v42, v100, v16, 0
  v_dot2_f32_bf16 v42, v101, v17, v42
  v_dot2_f32_bf16 v42, v102, v18, v42
  v_dot2_f32_bf16 v42, v103, v19, v42
  s_waitcnt vmcnt(4)
  buffer_load_dwordx4 v[124:127], v2, s[32:35], s44 offen offset:128 nt
  v_dot2_f32_bf16 v43, v104, v20, 0
  v_dot2_f32_bf16 v43, v105, v21, v43
  v_dot2_f32_bf16 v43, v106, v22, v43
  v_dot2_f32_bf16 v43, v107, v23, v43
  v_add_f32 v41, v41, v42
  s_nop 1
  v_add_f32 v41, v41, v43
  s_nop 1
  v_add_f32_dpp v41, v41, v41 quad_perm:[1,0,3,2] row_mask:0xf bank_mask:0xf
  s_nop 1
  v_add_f32_dpp v41, v41, v41 quad_perm:[2,3,0,1] row_mask:0xf bank_mask:0xf
  s_nop 1
  v_add_f32_dpp v41, v41, v41 row_half_mirror row_mask:0xf bank_mask:0xf
  v_cndmask_b32 v36, v36, v41, s[70:71]
  s_waitcnt vmcnt(4)
  buffer_load_dwordx4 v[128:131], v2, s[32:35], s44 offen offset:256 nt
  s_add_u32 s44, s44, 393216
  v_dot2_f32_bf16 v41, v108, v12, 0
  v_dot2_f32_bf16 v41, v109, v13, v41
  v_dot2_f32_bf16 v41, v110, v14, v41
  v_dot2_f32_bf16 v41, v111, v15, v41
  s_waitcnt vmcnt(4)
  buffer_load_dwordx4 v[132:135], v2, s[32:35], s44 offen offset:0 nt
  v_dot2_f32_bf16 v42, v112, v16, 0
  v_dot2_f32_bf16 v42, v113, v17, v42
  v_dot2_f32_bf16 v42, v114, v18, v42
  v_dot2_f32_bf16 v42, v115, v19, v42
  s_waitcnt vmcnt(4)
  buffer_load_dwordx4 v[136:139], v2, s[32:35], s44 offen offset:128 nt
  v_dot2_f32_bf16 v43, v116, v20, 0
  v_dot2_f32_bf16 v43, v117, v21, v43
  v_dot2_f32_bf16 v43, v118, v22, v43
  v_dot2_f32_bf16 v43, v119, v23, v43
  v_add_f32 v41, v41, v42
  s_nop 1
  v_add_f32 v41, v41, v43
  s_nop 1
  v_add_f32_dpp v41, v41, v41 quad_perm:[1,0,3,2] row_mask:0xf bank_mask:0xf
  s_nop 1
  v_add_f32_dpp v41, v41, v41 quad_perm:[2,3,0,1] row_mask:0xf bank_mask:0xf
  s_nop 1
  v_add_f32_dpp v41, v41, v41 row_half_mirror row_mask:0xf bank_mask:0xf
  v_cndmask_b32 v36, v36, v41, s[72:73]
  s_waitcnt vmcnt(4)
  buffer_load_dwordx4 v[140:143], v2, s[32:35], s44 offen offset:256 nt
  s_add_u32 s44, s44, 393216
  v_dot2_f32_bf16 v41, v120, v12, 0
  v_dot2_f32_bf16 v41, v121, v13, v41
  v_dot2_f32_bf16 v41, v122, v14, v41
  v_dot2_f32_bf16 v41, v123, v15, v41
  s_waitcnt vmcnt(4)
  s_cmp_eq_u32 s45, 3
  s_nop 0
  s_cbranch_scc0 L_nosw9
  s_mul_i32 s57, s46, 12582912
  s_add_u32 s32, s8, s57
  s_addc_u32 s33, s9, 0
  s_mul_i32 s44, s47, 3072
L_nosw9:
  buffer_load_dwordx4 v[48:51], v2, s[32:35], s44 offen offset:0 nt
  v_dot2_f32_bf16 v42, v124, v16, 0
  v_dot2_f32_bf16 v42, v125, v17, v42
  v_dot2_f32_bf16 v42, v126, v18, v42
  v_dot2_f32_bf16 v42, v127, v19, v42
  s_waitcnt vmcnt(4)
  buffer_load_dwordx4 v[52:55], v2, s[32:35], s44 offen offset:128 nt
  v_dot2_f32_bf16 v43, v128, v20, 0
  v_dot2_f32_bf16 v43, v129, v21, v43
  v_dot2_f32_bf16 v43, v130, v22, v43
  v_dot2_f32_bf16 v43, v131, v23, v43
  v_add_f32 v41, v41, v42
  s_nop 1
  v_add_f32 v41, v41, v43
  s_nop 1
  v_add_f32_dpp v41, v41, v41 quad_perm:[1,0,3,2] row_mask:0xf bank_mask:0xf
  s_nop 1
  v_add_f32_dpp v41, v41, v41 quad_perm:[2,3,0,1] row_mask:0xf bank_mask:0xf
  s_nop 1
  v_add_f32_dpp v41, v41, v41 row_half_mirror row_mask:0xf bank_mask:0xf
  v_cndmask_b32 v36, v36, v41, s[74:75]
  s_waitcnt vmcnt(4)
  buffer_load_dwordx4 v[56:59], v2, s[32:35], s44 offen offset:256 nt
  s_add_u32 s44, s44, 393216
  v_dot2_f32_bf16 v41, v132, v12, 0
  v_dot2_f32_bf16 v41, v133, v13, v41
  v_dot2_f32_bf16 v41, v134, v14, v41
  v_dot2_f32_bf16 v41, v135, v15, v41
  s_waitcnt vmcnt(4)
  buffer_load_dwordx4 v[60:63], v2, s[32:35], s44 offen offset:0 nt
  v_dot2_f32_bf16 v42, v136, v16, 0
  v_dot2_f32_bf16 v42, v137, v17, v42
  v_dot2_f32_bf16 v42, v138, v18, v42
  v_dot2_f32_bf16 v42, v139, v19, v42
  s_waitcnt vmcnt(4)
  buffer_load_dwordx4 v[64:67], v2, s[32:35], s44 offen offset:128 nt
  v_dot2_f32_bf16 v43, v140, v20, 0
  v_dot2_f32_bf16 v43, v141, v21, v43
  v_dot2_f32_bf16 v43, v142, v22, v43
  v_dot2_f32_bf16 v43, v143, v23, v43
  v_add_f32 v41, v41, v42
  s_nop 1
  v_add_f32 v41, v41, v43
  s_nop 1
  v_add_f32_dpp v41, v41, v41 quad_perm:[1,0,3,2] row_mask:0xf bank_mask:0xf
  s_nop 1
  v_add_f32_dpp v41, v41, v41 quad_perm:[2,3,0,1] row_mask:0xf bank_mask:0xf
  s_nop 1
  v_add_f32_dpp v41, v41, v41 row_half_mirror row_mask:0xf bank_mask:0xf
  v_cndmask_b32 v36, v36, v41, s[76:77]
  s_mov_b32 s97, 0
  s_nop 0
  s_branch L_knext
L_kboost:
  s_cmp_eq_u32 s97, 0
  s_cbranch_scc0 L_kb0
  buffer_load_dwordx4 v[68:71], v2, s[32:35], s44 offen offset:256 nt
  s_add_u32 s44, s44, 393216
  buffer_load_dwordx4 v[72:75], v2, s[32:35], s44 offen offset:0 nt
L_kb0:
  s_waitcnt vmcnt(6)
  buffer_load_dwordx4 v[76:79], v2, s[32:35], s44 offen offset:128 nt
  v_dot2_f32_bf16 v41, v48, v12, 0
  v_dot2_f32_bf16 v41, v49, v13, v41
  v_dot2_f32_bf16 v41, v50, v14, v41
  v_dot2_f32_bf16 v41, v51, v15, v41
  s_waitcnt vmcnt(6)
  buffer_load_dwordx4 v[80:83], v2, s[32:35], s44 offen offset:256 nt
  s_add_u32 s44, s44, 393216
  v_dot2_f32_bf16 v42, v52, v16, 0
  v_dot2_f32_bf16 v42, v53, v17, v42
  v_dot2_f32_bf16 v42, v54, v18, v42
  v_dot2_f32_bf16 v42, v55, v19, v42
  s_waitcnt vmcnt(6)
  buffer_load_dwordx4 v[84:87], v2, s[32:35], s44 offen offset:0 nt
  v_dot2_f32_bf16 v43, v56, v20, 0
  v_dot2_f32_bf16 v43, v57, v21, v43
  v_dot2_f32_bf16 v43, v58, v22, v43
  v_dot2_f32_bf16 v43, v59, v23, v43
  v_add_f32 v41, v41, v42
  s_nop 1
  v_add_f32 v41, v41, v43
  s_nop 1
  v_add_f32_dpp v41, v41, v41 quad_perm:[1,0,3,2] row_mask:0xf bank_mask:0xf
  s_nop 1
  v_add_f32_dpp v41, v41, v41 quad_perm:[2,3,0,1] row_mask:0xf bank_mask:0xf
  s_nop 1
  v_add_f32_dpp v41, v41, v41 row_half_mirror row_mask:0xf bank_mask:0xf
  v_cndmask_b32 v36, v36, v41, s[62:63]
  s_waitcnt vmcnt(6)
  buffer_load_dwordx4 v[88:91], v2, s[32:35], s44 offen offset:128 nt
  v_dot2_f32_bf16 v41, v60, v12, 0
  v_dot2_f32_bf16 v41, v61, v13, v41
  v_dot2_f32_bf16 v41, v62, v14, v41
  v_dot2_f32_bf16 v41, v63, v15, v41
  s_waitcnt vmcnt(6)
  buffer_load_dwordx4 v[92:95], v2, s[32:35], s44 offen offset:256 nt
  s_add_u32 s44, s44, 393216
  v_dot2_f32_bf16 v42, v64, v16, 0
  v_dot2_f32_bf16 v42, v65, v17, v42
  v_dot2_f32_bf16 v42, v66, v18, v42
  v_dot2_f32_bf16 v42, v67, v19, v42
  s_waitcnt vmcnt(6)
  buffer_load_dwordx4 v[96:99], v2, s[32:35], s44 offen offset:0 nt
  v_dot2_f32_bf16 v43, v68, v20, 0
  v_dot2_f32_bf16 v43, v69, v21, v43
  v_dot2_f32_bf16 v43, v70, v22, v43
  v_dot2_f32_bf16 v43, v71, v23, v43
  v_add_f32 v41, v41, v42
  s_nop 1
  v_add_f32 v41, v41, v43
  s_nop 1
  v_add_f32_dpp v41, v41, v41 quad_perm:[1,0,3,2] row_mask:0xf bank_mask:0xf
  s_nop 1
  v_add_f32_dpp v41, v41, v41 quad_perm:[2,3,0,1] row_mask:0xf bank_mask:0xf
  s_nop 1
  v_add_f32_dpp v41, v41, v41 row_half_mirror row_mask:0xf bank_mask:0xf
  v_cndmask_b32 v36, v36, v41, s[64:65]
  s_waitcnt vmcnt(6)
  buffer_load_dwordx4 v[100:103], v2, s[32:35], s44 offen offset:128 nt
  v_dot2_f32_bf16 v41, v72, v12, 0
  v_dot2_f32_bf16 v41, v73, v13, v41
  v_dot2_f32_bf16 v41, v74, v14, v41
  v_dot2_f32_bf16 v41, v75, v15, v41
  s_waitcnt vmcnt(6)
  buffer_load_dwordx4 v[104:107], v2, s[32:35], s44 offen offset:256 nt
  s_add_u32 s44, s44, 393216
  v_dot2_f32_bf16 v42, v76, v16, 0
  v_dot2_f32_bf16 v42, v77, v17, v42
  v_dot2_f32_bf16 v42, v78, v18, v42
  v_dot2_f32_bf16 v42, v79, v19, v42
  s_waitcnt vmcnt(6)
  buffer_load_dwordx4 v[108:111], v2, s[32:35], s44 offen offset:0 nt
  v_dot2_f32_bf16 v43, v80, v20, 0
  v_dot2_f32_bf16 v43, v81, v21, v43
  v_dot2_f32_bf16 v43, v82, v22, v43
  v_dot2_f32_bf16 v43, v83, v23, v43
  v_add_f32 v41, v41, v42
  s_nop 1
  v_add_f32 v41, v41, v43
  s_nop 1
  v_add_f32_dpp v41, v41, v41 quad_perm:[1,0,3,2] row_mask:0xf bank_mask:0xf
  s_nop 1
  v_add_f32_dpp v41, v41, v41 quad_perm:[2,3,0,1] row_mask:0xf bank_mask:0xf
  s_nop 1
  v_add_f32_dpp v41, v41, v41 row_half_mirror row_mask:0xf bank_mask:0xf
  v_cndmask_b32 v36, v36, v41, s[66:67]
  s_waitcnt vmcnt(6)
  buffer_load_dwordx4 v[112:115], v2, s[32:35], s44 offen offset:128 nt
  v_dot2_f32_bf16 v41, v84, v12, 0
  v_dot2_f32_bf16 v41, v85, v13, v41
  v_dot2_f32_bf16 v41, v86, v14, v41
  v_dot2_f32_bf16 v41, v87, v15, v41
  s_waitcnt vmcnt(6)
  buffer_load_dwordx4 v[116:119], v2, s[32:35], s44 offen offset:256 nt
  s_add_u32 s44, s44, 393216
  v_dot2_f32_bf16 v42, v88, v16, 0
  v_dot2_f32_bf16 v42, v89, v17, v42
  v_dot2_f32_bf16 v42, v90, v18, v42
  v_dot2_f32_bf16 v42, v91, v19, v42
  s_waitcnt vmcnt(6)
  buffer_load_dwordx4 v[120:123], v2, s[32:35], s44 offen offset:0 nt
  v_dot2_f32_bf16 v43, v92, v20, 0
  v_dot2_f32_bf16 v43, v93, v21, v43
  v_dot2_f32_bf16 v43, v94, v22, v43
  v_dot2_f32_bf16 v43, v95, v23, v43
  v_add_f32 v41, v41, v42
  s_nop 1
  v_add_f32 v41, v41, v43
  s_nop 1
  v_add_f32_dpp v41, v41, v41 quad_perm:[1,0,3,2] row_mask:0xf bank_mask:0xf
  s_nop 1
  v_add_f32_dpp v41, v41, v41 quad_perm:[2,3,0,1] row_mask:0xf bank_mask:0xf
  s_nop 1
  v_add_f32_dpp v41, v41, v41 row_half_mirror row_mask:0xf bank_mask:0xf
  v_cndmask_b32 v36, v36, v41, s[68:69]
  s_waitcnt vmcnt(6)
  buffer_load_dwordx4 v[124:127], v2, s[32:35], s44 offen offset:128 nt
  ds_read_b32 v233, v232 offset:2052
  v_dot2_f32_bf16 v41, v96, v12, 0
  v_dot2_f32_bf16 v41, v97, v13, v41
  v_dot2_f32_bf16 v41, v98, v14, v41
  v_dot2_f32_bf16 v41, v99, v15, v41
  s_waitcnt vmcnt(6)
  buffer_load_dwordx4 v[128:131], v2, s[32:35], s44 offen offset:256 nt
  s_add_u32 s44, s44, 393216
  v_dot2_f32_bf16 v42, v100, v16, 0
  v_dot2_f32_bf16 v42, v101, v17, v42
  v_dot2_f32_bf16 v42, v102, v18, v42
  v_dot2_f32_bf16 v42, v103, v19, v42
  s_waitcnt vmcnt(6)
  buffer_load_dwordx4 v[132:135], v2, s[32:35], s44 offen offset:0 nt
  v_dot2_f32_bf16 v43, v104, v20, 0
  v_dot2_f32_bf16 v43, v105, v21, v43
  v_dot2_f32_bf16 v43, v106, v22, v43
  v_dot2_f32_bf16 v43, v107, v23, v43
  v_add_f32 v41, v41, v42
  s_nop 1
  v_add_f32 v41, v41, v43
  s_nop 1
  v_add_f32_dpp v41, v41, v41 quad_perm:[1,0,3,2] row_mask:0xf bank_mask:0xf
  s_nop 1
  v_add_f32_dpp v41, v41, v41 quad_perm:[2,3,0,1] row_mask:0xf bank_mask:0xf
  s_nop 1
  v_add_f32_dpp v41, v41, v41 row_half_mirror row_mask:0xf bank_mask:0xf
  v_cndmask_b32 v36, v36, v41, s[70:71]
  s_waitcnt vmcnt(6)
  buffer_load_dwordx4 v[136:139], v2, s[32:35], s44 offen offset:128 nt
  v_dot2_f32_bf16 v41, v108, v12, 0
  v_dot2_f32_bf16 v41, v109, v13, v41
  v_dot2_f32_bf16 v41, v110, v14, v41
  v_dot2_f32_bf16 v41, v111, v15, v41
  s_waitcnt vmcnt(6)
  buffer_load_dwordx4 v[140:143], v2, s[32:35], s44 offen offset:256 nt
  s_add_u32 s44, s44, 393216
  v_dot2_f32_bf16 v42, v112, v16, 0
  v_dot2_f32_bf16 v42, v113, v17, v42
  v_dot2_f32_bf16 v42, v114, v18, v42
  v_dot2_f32_bf16 v42, v115, v19, v42
  s_waitcnt vmcnt(6)
  s_cmp_eq_u32 s45, 3
  s_nop 0
  s_cbranch_scc0 L_nosw10
  s_mul_i32 s57, s46, 12582912
  s_add_u32 s32, s8, s57
  s_addc_u32 s33, s9, 0
  s_mul_i32 s44, s47, 3072
L_nosw10:
  buffer_load_dwordx4 v[48:51], v2, s[32:35], s44 offen offset:0 nt
  v_dot2_f32_bf16 v43, v116, v20, 0
  v_dot2_f32_bf16 v43, v117, v21, v43
  v_dot2_f32_bf16 v43, v118, v22, v43
  v_dot2_f32_bf16 v43, v119, v23, v43
  v_add_f32 v41, v41, v42
  s_nop 1
  v_add_f32 v41, v41, v43
  s_nop 1
  v_add_f32_dpp v41, v41, v41 quad_perm:[1,0,3,2] row_mask:0xf bank_mask:0xf
  s_nop 1
  v_add_f32_dpp v41, v41, v41 quad_perm:[2,3,0,1] row_mask:0xf bank_mask:0xf
  s_nop 1
  v_add_f32_dpp v41, v41, v41 row_half_mirror row_mask:0xf bank_mask:0xf
  v_cndmask_b32 v36, v36, v41, s[72:73]
  s_waitcnt vmcnt(6)
  buffer_load_dwordx4 v[52:55], v2, s[32:35], s44 offen offset:128 nt
  v_dot2_f32_bf16 v41, v120, v12, 0
  v_dot2_f32_bf16 v41, v121, v13, v41
  v_dot2_f32_bf16 v41, v122, v14, v41
  v_dot2_f32_bf16 v41, v123, v15, v41
  s_waitcnt vmcnt(6)
  buffer_load_dwordx4 v[56:59], v2, s[32:35], s44 offen offset:256 nt
  s_add_u32 s44, s44, 393216
  v_dot2_f32_bf16 v42, v124, v16, 0
  v_dot2_f32_bf16 v42, v125, v17, v42
  v_dot2_f32_bf16 v42, v126, v18, v42
  v_dot2_f32_bf16 v42, v127, v19, v42
  s_waitcnt vmcnt(6)
  buffer_load_dwordx4 v[60:63], v2, s[32:35], s44 offen offset:0 nt
  v_dot2_f32_bf16 v43, v128, v20, 0
  v_dot2_f32_bf16 v43, v129, v21, v43
  v_dot2_f32_bf16 v43, v130, v22, v43
  v_dot2_f32_bf16 v43, v131, v23, v43
  v_add_f32 v41, v41, v42
  s_nop 1
  v_add_f32 v41, v41, v43
  s_nop 1
  v_add_f32_dpp v41, v41, v41 quad_perm:[1,0,3,2] row_mask:0xf bank_mask:0xf
  s_nop 1
  v_add_f32_dpp v41, v41, v41 quad_perm:[2,3,0,1] row_mask:0xf bank_mask:0xf
  s_nop 1
  v_add_f32_dpp v41, v41, v41 row_half_mirror row_mask:0xf bank_mask:0xf
  v_cndmask_b32 v36, v36, v41, s[74:75]
  s_waitcnt vmcnt(6)
  buffer_load_dwordx4 v[64:67], v2, s[32:35], s44 offen offset:128 nt
  v_dot2_f32_bf16 v41, v132, v12, 0
  v_dot2_f32_bf16 v41, v133, v13, v41
  v_dot2_f32_bf16 v41, v134, v14, v41
  v_dot2_f32_bf16 v41, v135, v15, v41
  s_waitcnt vmcnt(6)
  buffer_load_dwordx4 v[68:71], v2, s[32:35], s44 offen offset:256 nt
  s_add_u32 s44, s44, 393216
  v_dot2_f32_bf16 v42, v136, v16, 0
  v_dot2_f32_bf16 v42, v137, v17, v42
  v_dot2_f32_bf16 v42, v138, v18, v42
  v_dot2_f32_bf16 v42, v139, v19, v42
  s_waitcnt vmcnt(6)
  buffer_load_dwordx4 v[72:75], v2, s[32:35], s44 offen offset:0 nt
  v_dot2_f32_bf16 v43, v140, v20, 0
  v_dot2_f32_bf16 v43, v141, v21, v43
  v_dot2_f32_bf16 v43, v142, v22, v43
  v_dot2_f32_bf16 v43, v143, v23, v43
  v_add_f32 v41, v41, v42
  s_nop 1
  v_add_f32 v41, v41, v43
  s_nop 1
  v_add_f32_dpp v41, v41, v41 quad_perm:[1,0,3,2] row_mask:0xf bank_mask:0xf
  s_nop 1
  v_add_f32_dpp v41, v41, v41 quad_perm:[2,3,0,1] row_mask:0xf bank_mask:0xf
  s_nop 1
  v_add_f32_dpp v41, v41, v41 row_half_mirror row_mask:0xf bank_mask:0xf
  v_cndmask_b32 v36, v36, v41, s[76:77]
  s_mov_b32 s97, 1
  s_nop 0
L_knext:
  v_cvt_pk_bf16_f32 v41, v36, v36
  v_lshlrev_b32 v41, 16, v41
  v_mul_f32 v41, 0x3d93cd3a, v41
  v_cvt_pk_bf16_f32 v41, v41, v41
  v_lshlrev_b32 v41, 16, v41
  ds_write_b32 v47, v41 offset:25088
  v_add_u32 v47, 256, v47
  v_max_f32 v42, v37, v41
  v_sub_f32 v43, v37, v42
  v_sub_f32 v41, v41, v42
  v_mul_f32 v43, 0x3fb8aa3b, v43
  v_mul_f32 v41, 0x3fb8aa3b, v41
  v_exp_f32 v43, v43
  v_exp_f32 v41, v41
  v_mov_b32 v37, v42
  v_fma_f32 v224, v224, v43, v41
  s_add_u32 s98, s98, 1
  s_cmp_lg_u32 s3, 0
  s_cbranch_scc1 L_pg11
  v_mov_b32 v46, s98
  ds_write_b32 v232, v46 offset:2048
  s_nop 0
L_pg11:
  s_add_u32 s45, s45, 1
  s_cmp_lt_u32 s45, 4
  s_cbranch_scc1 L_kloop
  s_cmp_eq_u32 s97, 1
  s_cbranch_scc1 L_dp12
  buffer_load_dwordx4 v[68:71], v2, s[32:35], s44 offen offset:256 nt
  s_add_u32 s44, s44, 393216
  buffer_load_dwordx4 v[72:75], v2, s[32:35], s44 offen offset:0 nt
  s_mov_b32 s97, 1
L_dp12:
  v_mov_b32 v43, v37
  v_max_f32_dpp v37, v37, v37 quad_perm:[1,0,3,2] row_mask:0xf bank_mask:0xf
  s_nop 1
  v_max_f32_dpp v37, v37, v37 quad_perm:[2,3,0,1] row_mask:0xf bank_mask:0xf
  s_nop 1
  v_max_f32_dpp v37, v37, v37 row_half_mirror row_mask:0xf bank_mask:0xf
  s_nop 1
  v_max_f32_dpp v37, v37, v37 row_mirror row_mask:0xf bank_mask:0xf
  v_mov_b32 v41, v37
  s_nop 1
  v_permlane16_swap_b32 v41, v37
  v_max_f32 v37, v37, v41
  v_mov_b32 v41, v37
  s_nop 1
  v_permlane32_swap_b32 v41, v37
  v_max_f32 v37, v37, v41
  v_sub_f32 v43, v43, v37
  v_mul_f32 v43, 0x3fb8aa3b, v43
  v_exp_f32 v43, v43
  s_nop 0
  v_mul_f32 v224, v224, v43
  s_nop 1
  v_add_f32_dpp v224, v224, v224 quad_perm:[1,0,3,2] row_mask:0xf bank_mask:0xf
  s_nop 1
  v_add_f32_dpp v224, v224, v224 quad_perm:[2,3,0,1] row_mask:0xf bank_mask:0xf
  s_nop 1
  v_add_f32_dpp v224, v224, v224 row_half_mirror row_mask:0xf bank_mask:0xf
  s_nop 1
  v_add_f32_dpp v224, v224, v224 row_mirror row_mask:0xf bank_mask:0xf
  v_mov_b32 v41, v224
  s_nop 1
  v_permlane16_swap_b32 v41, v224
  v_add_f32 v224, v224, v41
  v_mov_b32 v41, v224
  s_nop 1
  v_permlane32_swap_b32 v41, v224
  v_add_f32 v224, v224, v41
  v_mov_b32 v8, v37
  v_mov_b32 v9, v224
  v_mov_b32 v10, 0
  v_mov_b32 v11, 0
  v_perm_b32 v8, v8, v3, s52
  v_perm_b32 v9, v9, v3, s53
  v_perm_b32 v10, v10, v3, s54
  v_perm_b32 v11, v11, v3, s55
  s_lshl_b32 s57, s46, 11
  s_lshl_b32 s58, s47, 4
  s_add_u32 s57, s57, s58
  s_add_u32 s57, s57, 294912
  v_mov_b32 v41, 0
  s_mov_b64 exec, 1
  s_cmp_eq_u32 s30, 1
  s_cbranch_scc1 L_pl13
  buffer_store_dwordx4 v[8:11], v41, s[36:39], s57 offen sc1
  s_nop 1
  s_branch L_pd13
L_pl13:
  buffer_store_dwordx4 v[8:11], v41, s[36:39], s57 offen
  s_nop 1
L_pd13:
  s_mov_b64 exec, -1
  v_mov_b32 v24, 0
  v_mov_b32 v25, 0
  v_mov_b32 v26, 0
  v_mov_b32 v27, 0
  v_mov_b32 v28, 0
  v_mov_b32 v29, 0
  v_mov_b32 v30, 0
  v_mov_b32 v31, 0
  v_mov_b32 v32, 0
  v_mov_b32 v33, 0
  v_mov_b32 v34, 0
  v_mov_b32 v35, 0
  v_lshlrev_b32 v47, 2, v1
  s_lshl_b32 s57, s3, 12
  v_add_u32 v47, s57, v47
  s_waitcnt lgkmcnt(0)
  ds_read_b32 v39, v47 offset:25088
  s_mov_b32 s45, 0
  s_cmp_lg_u32 s48, 0
  s_cbranch_scc1 L_vloop
  s_cmp_eq_u32 s50, 1
  s_cbranch_scc1 L_wF
  s_cmp_eq_u32 s50, 2
  s_cbranch_scc1 L_wR
  s_mul_i32 s57, s99, 48
  s_mul_i32 s58, s3, 12
  s_add_u32 s57, s57, s58
  v_lshrrev_b32 v41, 4, v1
  v_add_u32 v41, s57, v41
  v_mul_u32_u24 v41, 1280, v41
  v_and_b32 v42, 15, v1
  v_lshlrev_b32 v42, 4, v42
  v_add_u32 v41, v41, v42
  v_mov_b32 v42, s13
  v_add_co_u32 v228, vcc, s12, v41
  s_nop 1
  v_addc_co_u32 v229, vcc, 0, v42, vcc
  v_add_co_u32 v230, vcc, 10240, v228
  s_nop 1
  v_addc_co_u32 v231, vcc, 0, v229, vcc
  s_mov_b32 s61, 256
  s_mov_b32 s80, 4096
  s_nop 2
  s_branch L_wdone
L_wF:
  v_lshrrev_b32 v41, 2, v1
  s_mul_i32 s57, s3, 160
  v_add_u32 v41, s57, v41
  v_mul_u32_u24 v41, 3072, v41
  v_and_b32 v42, 1, v1
  v_lshlrev_b32 v42, 4, v42
  v_add_u32 v41, v41, v42
  s_lshl_b32 s57, s51, 5
  v_add_u32 v41, s57, v41
  v_mov_b32 v43, s18
  v_mov_b32 v44, s19
  v_mov_b32 v45, s20
  v_mov_b32 v46, s21
  v_and_b32 v42, 2, v1
  v_cmp_ne_u32 vcc, 0, v42
  s_nop 1
  v_cndmask_b32 v43, v43, v45, vcc
  v_cndmask_b32 v44, v44, v46, vcc
  v_add_co_u32 v228, vcc, v43, v41
  s_nop 1
  v_addc_co_u32 v229, vcc, 0, v44, vcc
  s_lshl_b32 s57, s51, 4
  s_lshl_b32 s58, s3, 2
  s_add_u32 s57, s57, s58
  v_lshrrev_b32 v41, 4, v1
  v_add_u32 v41, s57, v41
  v_mul_u32_u24 v41, 1280, v41
  v_and_b32 v42, 15, v1
  v_lshlrev_b32 v42, 4, v42
  v_add_u32 v41, v41, v42
  v_mov_b32 v42, s23
  v_add_co_u32 v230, vcc, s22, v41
  s_nop 1
  v_addc_co_u32 v231, vcc, 0, v42, vcc
  s_mov_b32 s61, 49152
  s_mov_b32 s80, 49152
  s_nop 2
  s_branch L_wdone
L_wR:
  v_mov_b32 v228, s12
  v_mov_b32 v229, s13
  v_mov_b32 v230, s12
  v_mov_b32 v231, s13
  s_mov_b32 s61, 0
  s_mov_b32 s80, 0
L_wdone:
  s_waitcnt lgkmcnt(0)
  v_sub_f32 v38, v39, v37
  v_add_u32 v47, 256, v47
  ds_read_b32 v39, v47 offset:25088
  v_mul_f32 v38, 0x3fb8aa3b, v38
  v_exp_f32 v38, v38
  s_nop 0
  v_cvt_pk_bf16_f32 v38, v38, v38
  s_waitcnt vmcnt(7)
  global_load_dwordx4 v[144:147], v[228:229], off nt
  v_add_co_u32 v228, vcc, s61, v228
  s_nop 1
  v_addc_co_u32 v229, vcc, 0, v229, vcc
  v_mov_b32_dpp v40, v38 row_newbcast:0 row_mask:0xf bank_mask:0x3
  s_nop 1
  v_mov_b32_dpp v40, v38 row_newbcast:8 row_mask:0xf bank_mask:0xc
  v_and_b32 v8, v40, v4
  v_and_b32 v9, v40, v5
  v_and_b32 v10, v40, v6
  v_and_b32 v11, v40, v7
  s_nop 1
  v_mfma_f32_16x16x32_bf16 v[24:27], v[8:11], v[48:51], v[24:27]
  s_waitcnt vmcnt(7)
  v_mfma_f32_16x16x32_bf16 v[28:31], v[8:11], v[52:55], v[28:31]
  s_waitcnt vmcnt(6)
  buffer_load_dwordx4 v[76:79], v2, s[32:35], s44 offen offset:128 nt
  v_mfma_f32_16x16x32_bf16 v[32:35], v[8:11], v[56:59], v[32:35]
  s_waitcnt vmcnt(6)
  buffer_load_dwordx4 v[80:83], v2, s[32:35], s44 offen offset:256 nt
  s_add_u32 s44, s44, 393216
  global_load_dwordx4 v[148:151], v[228:229], off nt
  v_add_co_u32 v228, vcc, s61, v228
  s_nop 1
  v_addc_co_u32 v229, vcc, 0, v229, vcc
  v_mov_b32_dpp v40, v38 row_newbcast:1 row_mask:0xf bank_mask:0x3
  s_nop 1
  v_mov_b32_dpp v40, v38 row_newbcast:9 row_mask:0xf bank_mask:0xc
  v_and_b32 v8, v40, v4
  v_and_b32 v9, v40, v5
  v_and_b32 v10, v40, v6
  v_and_b32 v11, v40, v7
  s_nop 1
  v_mfma_f32_16x16x32_bf16 v[24:27], v[8:11], v[60:63], v[24:27]
  s_waitcnt vmcnt(7)
  buffer_load_dwordx4 v[84:87], v2, s[32:35], s44 offen offset:0 nt
  v_mfma_f32_16x16x32_bf16 v[28:31], v[8:11], v[64:67], v[28:31]
  s_waitcnt vmcnt(7)
  buffer_load_dwordx4 v[88:91], v2, s[32:35], s44 offen offset:128 nt
  v_mfma_f32_16x16x32_bf16 v[32:35], v[8:11], v[68:71], v[32:35]
  s_waitcnt vmcnt(7)
  buffer_load_dwordx4 v[92:95], v2, s[32:35], s44 offen offset:256 nt
  s_add_u32 s44, s44, 393216
  global_load_dwordx4 v[152:155], v[228:229], off nt
  v_add_co_u32 v228, vcc, s61, v228
  s_nop 1
  v_addc_co_u32 v229, vcc, 0, v229, vcc
  v_mov_b32_dpp v40, v38 row_newbcast:2 row_mask:0xf bank_mask:0x3
  s_nop 1
  v_mov_b32_dpp v40, v38 row_newbcast:10 row_mask:0xf bank_mask:0xc
  v_and_b32 v8, v40, v4
  v_and_b32 v9, v40, v5
  v_and_b32 v10, v40, v6
  v_and_b32 v11, v40, v7
  s_nop 1
  v_mfma_f32_16x16x32_bf16 v[24:27], v[8:11], v[72:75], v[24:27]
  s_waitcnt vmcnt(6)
  buffer_load_dwordx4 v[96:99], v2, s[32:35], s44 offen offset:0 nt
  v_mfma_f32_16x16x32_bf16 v[28:31], v[8:11], v[76:79], v[28:31]
  s_waitcnt vmcnt(6)
  buffer_load_dwordx4 v[100:103], v2, s[32:35], s44 offen offset:128 nt
  v_mfma_f32_16x16x32_bf16 v[32:35], v[8:11], v[80:83], v[32:35]
  s_waitcnt vmcnt(5)
  buffer_load_dwordx4 v[104:107], v2, s[32:35], s44 offen offset:256 nt
  s_add_u32 s44, s44, 393216
  global_load_dwordx4 v[156:159], v[228:229], off nt
  v_add_co_u32 v228, vcc, s61, v228
  s_nop 1
  v_addc_co_u32 v229, vcc, 0, v229, vcc
  v_mov_b32_dpp v40, v38 row_newbcast:3 row_mask:0xf bank_mask:0x3
  s_nop 1
  v_mov_b32_dpp v40, v38 row_newbcast:11 row_mask:0xf bank_mask:0xc
  v_and_b32 v8, v40, v4
  v_and_b32 v9, v40, v5
  v_and_b32 v10, v40, v6
  v_and_b32 v11, v40, v7
  s_nop 1
  v_mfma_f32_16x16x32_bf16 v[24:27], v[8:11], v[84:87], v[24:27]
  s_waitcnt vmcnt(6)
  buffer_load_dwordx4 v[108:111], v2, s[32:35], s44 offen offset:0 nt
  v_mfma_f32_16x16x32_bf16 v[28:31], v[8:11], v[88:91], v[28:31]
  s_waitcnt vmcnt(6)
  buffer_load_dwordx4 v[112:115], v2, s[32:35], s44 offen offset:128 nt
  v_mfma_f32_16x16x32_bf16 v[32:35], v[8:11], v[92:95], v[32:35]
  s_waitcnt vmcnt(5)
  buffer_load_dwordx4 v[116:119], v2, s[32:35], s44 offen offset:256 nt
  s_add_u32 s44, s44, 393216
  global_load_dwordx4 v[160:163], v[228:229], off nt
  v_add_co_u32 v228, vcc, s80, v228
  s_nop 1
  v_addc_co_u32 v229, vcc, 0, v229, vcc
  v_mov_b32_dpp v40, v38 row_newbcast:4 row_mask:0xf bank_mask:0x3
  s_nop 1
  v_mov_b32_dpp v40, v38 row_newbcast:12 row_mask:0xf bank_mask:0xc
  v_and_b32 v8, v40, v4
  v_and_b32 v9, v40, v5
  v_and_b32 v10, v40, v6
  v_and_b32 v11, v40, v7
  s_nop 1
  v_mfma_f32_16x16x32_bf16 v[24:27], v[8:11], v[96:99], v[24:27]
  s_waitcnt vmcnt(6)
  buffer_load_dwordx4 v[120:123], v2, s[32:35], s44 offen offset:0 nt
  v_mfma_f32_16x16x32_bf16 v[28:31], v[8:11], v[100:103], v[28:31]
  s_waitcnt vmcnt(6)
  buffer_load_dwordx4 v[124:127], v2, s[32:35], s44 offen offset:128 nt
  v_mfma_f32_16x16x32_bf16 v[32:35], v[8:11], v[104:107], v[32:35]
  s_waitcnt vmcnt(5)
  buffer_load_dwordx4 v[128:131], v2, s[32:35], s44 offen offset:256 nt
  s_add_u32 s44, s44, 393216
  global_load_dwordx4 v[164:167], v[228:229], off nt
  v_add_co_u32 v228, vcc, s61, v228
  s_nop 1
  v_addc_co_u32 v229, vcc, 0, v229, vcc
  v_mov_b32_dpp v40, v38 row_newbcast:5 row_mask:0xf bank_mask:0x3
  s_nop 1
  v_mov_b32_dpp v40, v38 row_newbcast:13 row_mask:0xf bank_mask:0xc
  v_and_b32 v8, v40, v4
  v_and_b32 v9, v40, v5
  v_and_b32 v10, v40, v6
  v_and_b32 v11, v40, v7
  s_nop 1
  v_mfma_f32_16x16x32_bf16 v[24:27], v[8:11], v[108:111], v[24:27]
  s_waitcnt vmcnt(6)
  buffer_load_dwordx4 v[132:135], v2, s[32:35], s44 offen offset:0 nt
  v_mfma_f32_16x16x32_bf16 v[28:31], v[8:11], v[112:115], v[28:31]
  s_waitcnt vmcnt(6)
  buffer_load_dwordx4 v[136:139], v2, s[32:35], s44 offen offset:128 nt
  v_mfma_f32_16x16x32_bf16 v[32:35], v[8:11], v[116:119], v[32:35]
  s_waitcnt vmcnt(5)
  buffer_load_dwordx4 v[140:143], v2, s[32:35], s44 offen offset:256 nt
  s_add_u32 s44, s44, 393216
  global_load_dwordx4 v[168:171], v[228:229], off nt
  v_add_co_u32 v228, vcc, s61, v228
  s_nop 1
  v_addc_co_u32 v229, vcc, 0, v229, vcc
  v_mov_b32_dpp v40, v38 row_newbcast:6 row_mask:0xf bank_mask:0x3
  s_nop 1
  v_mov_b32_dpp v40, v38 row_newbcast:14 row_mask:0xf bank_mask:0xc
  v_and_b32 v8, v40, v4
  v_and_b32 v9, v40, v5
  v_and_b32 v10, v40, v6
  v_and_b32 v11, v40, v7
  s_nop 1
  v_mfma_f32_16x16x32_bf16 v[24:27], v[8:11], v[120:123], v[24:27]
  s_waitcnt vmcnt(6)
  buffer_load_dwordx4 v[48:51], v2, s[32:35], s44 offen offset:0 nt
  v_mfma_f32_16x16x32_bf16 v[28:31], v[8:11], v[124:127], v[28:31]
  s_waitcnt vmcnt(6)
  buffer_load_dwordx4 v[52:55], v2, s[32:35], s44 offen offset:128 nt
  v_mfma_f32_16x16x32_bf16 v[32:35], v[8:11], v[128:131], v[32:35]
  s_waitcnt vmcnt(5)
  buffer_load_dwordx4 v[56:59], v2, s[32:35], s44 offen offset:256 nt
  s_add_u32 s44, s44, 393216
  global_load_dwordx4 v[172:175], v[228:229], off nt
  v_add_co_u32 v228, vcc, s61, v228
  s_nop 1
  v_addc_co_u32 v229, vcc, 0, v229, vcc
  v_mov_b32_dpp v40, v38 row_newbcast:7 row_mask:0xf bank_mask:0x3
  s_nop 1
  v_mov_b32_dpp v40, v38 row_newbcast:15 row_mask:0xf bank_mask:0xc
  v_and_b32 v8, v40, v4
  v_and_b32 v9, v40, v5
  v_and_b32 v10, v40, v6
  v_and_b32 v11, v40, v7
  s_nop 1
  v_mfma_f32_16x16x32_bf16 v[24:27], v[8:11], v[132:135], v[24:27]
  s_waitcnt vmcnt(6)
  buffer_load_dwordx4 v[60:63], v2, s[32:35], s44 offen offset:0 nt
  v_mfma_f32_16x16x32_bf16 v[28:31], v[8:11], v[136:139], v[28:31]
  s_waitcnt vmcnt(6)
  buffer_load_dwordx4 v[64:67], v2, s[32:35], s44 offen offset:128 nt
  v_mfma_f32_16x16x32_bf16 v[32:35], v[8:11], v[140:143], v[32:35]
  s_add_u32 s98, s98, 1
  s_cmp_lg_u32 s3, 0
  s_nop 5
  s_cbranch_scc1 L_pg14
  v_mov_b32 v46, s98
  ds_write_b32 v232, v46 offset:2048
  s_nop 0
L_pg14:
  s_waitcnt lgkmcnt(0)
  v_sub_f32 v38, v39, v37
  v_add_u32 v47, 256, v47
  ds_read_b32 v39, v47 offset:25088
  v_mul_f32 v38, 0x3fb8aa3b, v38
  v_exp_f32 v38, v38
  s_nop 0
  v_cvt_pk_bf16_f32 v38, v38, v38
  s_waitcnt vmcnt(5)
  buffer_load_dwordx4 v[68:71], v2, s[32:35], s44 offen offset:256 nt
  s_add_u32 s44, s44, 393216
  global_load_dwordx4 v[176:179], v[228:229], off nt
  v_add_co_u32 v228, vcc, s61, v228
  s_nop 1
  v_addc_co_u32 v229, vcc, 0, v229, vcc
  v_mov_b32_dpp v40, v38 row_newbcast:0 row_mask:0xf bank_mask:0x3
  s_nop 1
  v_mov_b32_dpp v40, v38 row_newbcast:8 row_mask:0xf bank_mask:0xc
  v_and_b32 v8, v40, v4
  v_and_b32 v9, v40, v5
  v_and_b32 v10, v40, v6
  v_and_b32 v11, v40, v7
  s_nop 1
  v_mfma_f32_16x16x32_bf16 v[24:27], v[8:11], v[48:51], v[24:27]
  s_waitcnt vmcnt(6)
  buffer_load_dwordx4 v[72:75], v2, s[32:35], s44 offen offset:0 nt
  v_mfma_f32_16x16x32_bf16 v[28:31], v[8:11], v[52:55], v[28:31]
  s_waitcnt vmcnt(6)
  buffer_load_dwordx4 v[76:79], v2, s[32:35], s44 offen offset:128 nt
  v_mfma_f32_16x16x32_bf16 v[32:35], v[8:11], v[56:59], v[32:35]
  s_waitcnt vmcnt(5)
  buffer_load_dwordx4 v[80:83], v2, s[32:35], s44 offen offset:256 nt
  s_add_u32 s44, s44, 393216
  global_load_dwordx4 v[180:183], v[228:229], off nt
  v_mov_b32_dpp v40, v38 row_newbcast:1 row_mask:0xf bank_mask:0x3
  s_nop 1
  v_mov_b32_dpp v40, v38 row_newbcast:9 row_mask:0xf bank_mask:0xc
  v_and_b32 v8, v40, v4
  v_and_b32 v9, v40, v5
  v_and_b32 v10, v40, v6
  v_and_b32 v11, v40, v7
  s_nop 1
  v_mfma_f32_16x16x32_bf16 v[24:27], v[8:11], v[60:63], v[24:27]
  s_waitcnt vmcnt(6)
  buffer_load_dwordx4 v[84:87], v2, s[32:35], s44 offen offset:0 nt
  v_mfma_f32_16x16x32_bf16 v[28:31], v[8:11], v[64:67], v[28:31]
  s_waitcnt vmcnt(6)
  buffer_load_dwordx4 v[88:91], v2, s[32:35], s44 offen offset:128 nt
  v_mfma_f32_16x16x32_bf16 v[32:35], v[8:11], v[68:71], v[32:35]
  s_waitcnt vmcnt(5)
  buffer_load_dwordx4 v[92:95], v2, s[32:35], s44 offen offset:256 nt
  s_add_u32 s44, s44, 393216
  global_load_dwordx4 v[184:187], v[230:231], off offset:0 nt
  v_mov_b32_dpp v40, v38 row_newbcast:2 row_mask:0xf bank_mask:0x3
  s_nop 1
  v_mov_b32_dpp v40, v38 row_newbcast:10 row_mask:0xf bank_mask:0xc
  v_and_b32 v8, v40, v4
  v_and_b32 v9, v40, v5
  v_and_b32 v10, v40, v6
  v_and_b32 v11, v40, v7
  s_nop 1
  v_mfma_f32_16x16x32_bf16 v[24:27], v[8:11], v[72:75], v[24:27]
  s_waitcnt vmcnt(6)
  buffer_load_dwordx4 v[96:99], v2, s[32:35], s44 offen offset:0 nt
  v_mfma_f32_16x16x32_bf16 v[28:31], v[8:11], v[76:79], v[28:31]
  s_waitcnt vmcnt(6)
  buffer_load_dwordx4 v[100:103], v2, s[32:35], s44 offen offset:128 nt
  v_mfma_f32_16x16x32_bf16 v[32:35], v[8:11], v[80:83], v[32:35]
  s_waitcnt vmcnt(5)
  buffer_load_dwordx4 v[104:107], v2, s[32:35], s44 offen offset:256 nt
  s_add_u32 s44, s44, 393216
  global_load_dwordx4 v[188:191], v[230:231], off offset:256 nt
  v_mov_b32_dpp v40, v38 row_newbcast:3 row_mask:0xf bank_mask:0x3
  s_nop 1
  v_mov_b32_dpp v40, v38 row_newbcast:11 row_mask:0xf bank_mask:0xc
  v_and_b32 v8, v40, v4
  v_and_b32 v9, v40, v5
  v_and_b32 v10, v40, v6
  v_and_b32 v11, v40, v7
  s_nop 1
  v_mfma_f32_16x16x32_bf16 v[24:27], v[8:11], v[84:87], v[24:27]
  s_waitcnt vmcnt(6)
  buffer_load_dwordx4 v[108:111], v2, s[32:35], s44 offen offset:0 nt
  v_mfma_f32_16x16x32_bf16 v[28:31], v[8:11], v[88:91], v[28:31]
  s_waitcnt vmcnt(6)
  buffer_load_dwordx4 v[112:115], v2, s[32:35], s44 offen offset:128 nt
  v_mfma_f32_16x16x32_bf16 v[32:35], v[8:11], v[92:95], v[32:35]
  s_waitcnt vmcnt(5)
  buffer_load_dwordx4 v[116:119], v2, s[32:35], s44 offen offset:256 nt
  s_add_u32 s44, s44, 393216
  global_load_dwordx4 v[192:195], v[230:231], off offset:512 nt
  v_mov_b32_dpp v40, v38 row_newbcast:4 row_mask:0xf bank_mask:0x3
  s_nop 1
  v_mov_b32_dpp v40, v38 row_newbcast:12 row_mask:0xf bank_mask:0xc
  v_and_b32 v8, v40, v4
  v_and_b32 v9, v40, v5
  v_and_b32 v10, v40, v6
  v_and_b32 v11, v40, v7
  s_nop 1
  v_mfma_f32_16x16x32_bf16 v[24:27], v[8:11], v[96:99], v[24:27]
  s_waitcnt vmcnt(6)
  buffer_load_dwordx4 v[120:123], v2, s[32:35], s44 offen offset:0 nt
  v_mfma_f32_16x16x32_bf16 v[28:31], v[8:11], v[100:103], v[28:31]
  s_waitcnt vmcnt(6)
  buffer_load_dwordx4 v[124:127], v2, s[32:35], s44 offen offset:128 nt
  v_mfma_f32_16x16x32_bf16 v[32:35], v[8:11], v[104:107], v[32:35]
  s_waitcnt vmcnt(5)
  buffer_load_dwordx4 v[128:131], v2, s[32:35], s44 offen offset:256 nt
  s_add_u32 s44, s44, 393216
  global_load_dwordx4 v[196:199], v[230:231], off offset:768 nt
  v_mov_b32_dpp v40, v38 row_newbcast:5 row_mask:0xf bank_mask:0x3
  s_nop 1
  v_mov_b32_dpp v40, v38 row_newbcast:13 row_mask:0xf bank_mask:0xc
  v_and_b32 v8, v40, v4
  v_and_b32 v9, v40, v5
  v_and_b32 v10, v40, v6
  v_and_b32 v11, v40, v7
  s_nop 1
  v_mfma_f32_16x16x32_bf16 v[24:27], v[8:11], v[108:111], v[24:27]
  s_waitcnt vmcnt(6)
  buffer_load_dwordx4 v[132:135], v2, s[32:35], s44 offen offset:0 nt
  v_mfma_f32_16x16x32_bf16 v[28:31], v[8:11], v[112:115], v[28:31]
  s_waitcnt vmcnt(6)
  buffer_load_dwordx4 v[136:139], v2, s[32:35], s44 offen offset:128 nt
  v_mfma_f32_16x16x32_bf16 v[32:35], v[8:11], v[116:119], v[32:35]
  s_waitcnt vmcnt(5)
  buffer_load_dwordx4 v[140:143], v2, s[32:35], s44 offen offset:256 nt
  s_add_u32 s44, s44, 393216
  global_load_dwordx4 v[200:203], v[230:231], off offset:1024 nt
  v_mov_b32_dpp v40, v38 row_newbcast:6 row_mask:0xf bank_mask:0x3
  s_nop 1
  v_mov_b32_dpp v40, v38 row_newbcast:14 row_mask:0xf bank_mask:0xc
  v_and_b32 v8, v40, v4
  v_and_b32 v9, v40, v5
  v_and_b32 v10, v40, v6
  v_and_b32 v11, v40, v7
  s_nop 1
  v_mfma_f32_16x16x32_bf16 v[24:27], v[8:11], v[120:123], v[24:27]
  s_waitcnt vmcnt(6)
  buffer_load_dwordx4 v[48:51], v2, s[32:35], s44 offen offset:0 nt
  v_mfma_f32_16x16x32_bf16 v[28:31], v[8:11], v[124:127], v[28:31]
  s_waitcnt vmcnt(6)
  buffer_load_dwordx4 v[52:55], v2, s[32:35], s44 offen offset:128 nt
  v_mfma_f32_16x16x32_bf16 v[32:35], v[8:11], v[128:131], v[32:35]
  s_waitcnt vmcnt(5)
  buffer_load_dwordx4 v[56:59], v2, s[32:35], s44 offen offset:256 nt
  s_add_u32 s44, s44, 393216
  v_mov_b32_dpp v40, v38 row_newbcast:7 row_mask:0xf bank_mask:0x3
  s_nop 1
  v_mov_b32_dpp v40, v38 row_newbcast:15 row_mask:0xf bank_mask:0xc
  v_and_b32 v8, v40, v4
  v_and_b32 v9, v40, v5
  v_and_b32 v10, v40, v6
  v_and_b32 v11, v40, v7
  s_nop 1
  v_mfma_f32_16x16x32_bf16 v[24:27], v[8:11], v[132:135], v[24:27]
  s_waitcnt vmcnt(5)
  buffer_load_dwordx4 v[60:63], v2, s[32:35], s44 offen offset:0 nt
  v_mfma_f32_16x16x32_bf16 v[28:31], v[8:11], v[136:139], v[28:31]
  s_waitcnt vmcnt(5)
  buffer_load_dwordx4 v[64:67], v2, s[32:35], s44 offen offset:128 nt
  v_mfma_f32_16x16x32_bf16 v[32:35], v[8:11], v[140:143], v[32:35]
  s_add_u32 s98, s98, 1
  s_cmp_lg_u32 s3, 0
  s_nop 5
  s_cbranch_scc1 L_pg15
  v_mov_b32 v46, s98
  ds_write_b32 v232, v46 offset:2048
  s_nop 0
L_pg15:
  ds_read_b32 v233, v232 offset:2052
  s_mov_b32 s45, 2
  s_mov_b32 s97, 0
L_vloop:
  s_cmp_eq_u32 s45, 2
  s_cbranch_scc0 L_vh1
  s_lshl_b32 s57, s46, 11
  s_add_u32 s57, s57, 294912
  v_min_u32 v42, 127, v1
  v_lshlrev_b32 v42, 4, v42
  buffer_load_dwordx4 v[204:207], v42, s[36:39], s57 offen sc1
  buffer_load_dwordx4 v[208:211], v42, s[36:39], s57 offen offset:1024 sc1
  s_getpc_b64 s[58:59]
L_pc2:
  s_lshr_b32 s60, s2, 3
  s_lshl_b32 s60, s60, 9
  v_and_b32 v42, 7, v1
  v_lshlrev_b32 v42, 6, v42
  v_add_u32 v42, s60, v42
  v_add_u32 v42, L_tailcode-L_pc2, v42
  v_min_u32 v42, L_codeend-L_pc2-4, v42
  global_load_dword v43, v42, s[58:59]
  s_nop 0
L_vh1:
  s_cmp_eq_u32 s45, 3
  s_cbranch_scc0 L_vh2
L_tailcode:
  v_perm_b32 v41, v205, v204, s56
  v_perm_b32 v43, v207, v206, s56
  v_lshl_or_b32 v41, v43, 16, v41
  v_cmp_ne_u32 vcc, v41, v3
  s_mov_b64 s[84:85], vcc
  v_perm_b32 v41, v209, v208, s56
  v_perm_b32 v43, v211, v210, s56
  v_lshl_or_b32 v41, v43, 16, v41
  v_cmp_ne_u32 vcc, v41, v3
  s_or_b64 s[84:85], s[84:85], vcc
  s_cmp_eq_u64 s[84:85], 0
  s_nop 2
  s_cbranch_scc1 L_mlok
  s_mov_b32 s81, 524288
  s_lshl_b32 s57, s46, 11
  s_add_u32 s57, s57, 294912
  v_min_u32 v42, 127, v1
  v_lshlrev_b32 v42, 4, v42
  buffer_load_dwordx4 v[204:207], v42, s[36:39], s57 offen sc1
  buffer_load_dwordx4 v[208:211], v42, s[36:39], s57 offen offset:1024 sc1
  s_waitcnt vmcnt(0)
  s_branch L_pollchk16
L_poll16:
  s_sub_u32 s81, s81, 1
  s_cmp_eq_u32 s81, 0
  s_cbranch_scc1 L_abort
  s_lshl_b32 s57, s46, 11
  s_add_u32 s57, s57, 294912
  v_min_u32 v42, 127, v1
  v_lshlrev_b32 v42, 4, v42
  buffer_load_dwordx4 v[204:207], v42, s[36:39], s57 offen sc1
  buffer_load_dwordx4 v[208:211], v42, s[36:39], s57 offen offset:1024 sc1
  s_waitcnt vmcnt(0)
L_pollchk16:
  v_perm_b32 v41, v205, v204, s56
  v_perm_b32 v43, v207, v206, s56
  v_lshl_or_b32 v41, v43, 16, v41
  v_cmp_ne_u32 vcc, v41, v3
  s_mov_b64 s[84:85], vcc
  v_perm_b32 v41, v209, v208, s56
  v_perm_b32 v43, v211, v210, s56
  v_lshl_or_b32 v41, v43, 16, v41
  v_cmp_ne_u32 vcc, v41, v3
  s_or_b64 s[84:85], s[84:85], vcc
  s_cmp_lg_u64 s[84:85], 0
  s_nop 2
  s_cbranch_scc1 L_poll16
L_mlok:
  v_max_f32 v41, v204, v208
  v_and_b32 v41, 0xffffff00, v41
  s_nop 1
  v_max_f32_dpp v41, v41, v41 quad_perm:[1,0,3,2] row_mask:0xf bank_mask:0xf
  s_nop 1
  v_max_f32_dpp v41, v41, v41 quad_perm:[2,3,0,1] row_mask:0xf bank_mask:0xf
  s_nop 1
  v_max_f32_dpp v41, v41, v41 row_half_mirror row_mask:0xf bank_mask:0xf
  s_nop 1
  v_max_f32_dpp v41, v41, v41 row_mirror row_mask:0xf bank_mask:0xf
  v_mov_b32 v42, v41
  s_nop 1
  v_permlane16_swap_b32 v42, v41
  v_max_f32 v41, v41, v42
  v_mov_b32 v42, v41
  s_nop 1
  v_permlane32_swap_b32 v42, v41
  v_max_f32 v41, v41, v42
  v_and_b32 v204, 0xffffff00, v204
  v_and_b32 v205, 0xffffff00, v205
  v_sub_f32 v43, v204, v41
  v_mul_f32 v43, 0x3fb8aa3b, v43
  v_exp_f32 v43, v43
  s_nop 0
  v_mul_f32 v43, v43, v205
  v_and_b32 v208, 0xffffff00, v208
  v_and_b32 v209, 0xffffff00, v209
  v_sub_f32 v44, v208, v41
  v_mul_f32 v44, 0x3fb8aa3b, v44
  v_exp_f32 v44, v44
  s_nop 0
  v_fmac_f32 v43, v44, v209
  s_nop 1
  v_add_f32_dpp v43, v43, v43 quad_perm:[1,0,3,2] row_mask:0xf bank_mask:0xf
  s_nop 1
  v_add_f32_dpp v43, v43, v43 quad_perm:[2,3,0,1] row_mask:0xf bank_mask:0xf
  s_nop 1
  v_add_f32_dpp v43, v43, v43 row_half_mirror row_mask:0xf bank_mask:0xf
  s_nop 1
  v_add_f32_dpp v43, v43, v43 row_mirror row_mask:0xf bank_mask:0xf
  v_mov_b32 v42, v43
  s_nop 1
  v_permlane16_swap_b32 v42, v43
  v_add_f32 v43, v43, v42
  v_mov_b32 v42, v43
  s_nop 1
  v_permlane32_swap_b32 v42, v43
  v_add_f32 v43, v43, v42
  v_sub_f32 v44, v37, v41
  v_mul_f32 v44, 0x3fb8aa3b, v44
  v_exp_f32 v44, v44
  v_rcp_f32 v43, v43
  s_nop 0
  v_mul_f32 v225, v44, v43
  v_lshrrev_b32 v41, 5, v1
  v_mul_u32_u24 v226, 768, v41
  v_and_b32 v41, 7, v1
  v_lshlrev_b32 v41, 5, v41
  v_add_u32 v226, v226, v41
  v_and_b32 v41, 16, v1
  v_add_u32 v226, v226, v41
  s_mul_i32 s57, s3, 1536
  v_add_u32 v226, s57, v226
  v_mul_u32_u24 v42, 43691, v1
  v_lshrrev_b32 v42, 19, v42
  v_mul_u32_u24 v43, 12, v42
  v_sub_u32 v43, v1, v43
  v_mul_u32_u24 v42, 6144, v42
  v_lshlrev_b32 v43, 4, v43
  v_add_u32 v227, v42, v43
  s_mul_i32 s57, s46, 24576
  s_mul_i32 s58, s79, 192
  s_add_u32 s57, s57, s58
  s_add_u32 s87, s57, 393216
  s_cmp_lg_u32 s48, 3
  s_cbranch_scc1 L_vh2
  v_lshrrev_b32 v41, 5, v1
  v_lshlrev_b32 v41, 8, v41
  v_and_b32 v42, 7, v1
  v_lshlrev_b32 v42, 5, v42
  v_add_u32 v41, v41, v42
  v_and_b32 v42, 16, v1
  v_add_u32 v41, v41, v42
  s_mul_i32 s57, s3, 2560
  v_add_u32 v12, s57, v41
  s_mov_b32 s57, 16384
  s_cmp_eq_u32 s50, 1
  s_cselect_b32 s57, 12288, s57
  v_lshrrev_b32 v42, 3, v0
  v_mul_u32_u24 v42, s57, v42
  v_and_b32 v43, 7, v0
  v_lshlrev_b32 v43, 4, v43
  v_add_u32 v13, v42, v43
  v_mov_b32 v204, 0
  v_mov_b32 v205, 0
  v_mov_b32 v206, 0
  v_mov_b32 v207, 0
  v_mov_b32 v208, 0
  v_mov_b32 v209, 0
  v_mov_b32 v210, 0
  v_mov_b32 v211, 0
  v_mov_b32 v212, 0
  v_mov_b32 v213, 0
  v_mov_b32 v214, 0
  v_mov_b32 v215, 0
  v_mov_b32 v216, 0
  v_mov_b32 v217, 0
  v_mov_b32 v218, 0
  v_mov_b32 v219, 0
  v_mov_b32 v220, 0
  v_mov_b32 v221, 0
  v_mov_b32 v222, 0
  v_mov_b32 v223, 0
  s_nop 1
L_vh2:
  s_waitcnt lgkmcnt(0)
  v_sub_f32 v38, v39, v37
  v_add_u32 v47, 256, v47
  ds_read_b32 v39, v47 offset:25088
  v_mul_f32 v38, 0x3fb8aa3b, v38
  v_exp_f32 v38, v38
  s_nop 0
  v_cvt_pk_bf16_f32 v38, v38, v38
  s_waitcnt lgkmcnt(0)
  v_readfirstlane_b32 s31, v233
  s_cmp_eq_u32 s31, 1
  s_nop 3
  s_cbranch_scc1 L_vboost
  s_cmp_eq_u32 s97, 0
  s_cbranch_scc1 L_vn0
  s_waitcnt vmcnt(6)
  v_mov_b32_dpp v40, v38 row_newbcast:0 row_mask:0xf bank_mask:0x3
  s_nop 1
  v_mov_b32_dpp v40, v38 row_newbcast:8 row_mask:0xf bank_mask:0xc
  v_and_b32 v8, v40, v4
  v_and_b32 v9, v40, v5
  v_and_b32 v10, v40, v6
  v_and_b32 v11, v40, v7
  s_nop 1
  v_mfma_f32_16x16x32_bf16 v[24:27], v[8:11], v[48:51], v[24:27]
  s_waitcnt vmcnt(5)
  v_mfma_f32_16x16x32_bf16 v[28:31], v[8:11], v[52:55], v[28:31]
  s_nop 7
  s_branch L_vn1
L_vn0:
  s_waitcnt vmcnt(4)
  buffer_load_dwordx4 v[68:71], v2, s[32:35], s44 offen offset:256 nt
  s_add_u32 s44, s44, 393216
  v_mov_b32_dpp v40, v38 row_newbcast:0 row_mask:0xf bank_mask:0x3
  s_nop 1
  v_mov_b32_dpp v40, v38 row_newbcast:8 row_mask:0xf bank_mask:0xc
  v_and_b32 v8, v40, v4
  v_and_b32 v9, v40, v5
  v_and_b32 v10, v40, v6
  v_and_b32 v11, v40, v7
  s_nop 1
  v_mfma_f32_16x16x32_bf16 v[24:27], v[8:11], v[48:51], v[24:27]
  s_waitcnt vmcnt(4)
  buffer_load_dwordx4 v[72:75], v2, s[32:35], s44 offen offset:0 nt
  v_mfma_f32_16x16x32_bf16 v[28:31], v[8:11], v[52:55], v[28:31]
  s_nop 7
L_vn1:
  s_waitcnt vmcnt(4)
  buffer_load_dwordx4 v[76:79], v2, s[32:35], s44 offen offset:128 nt
  v_mfma_f32_16x16x32_bf16 v[32:35], v[8:11], v[56:59], v[32:35]
  s_waitcnt vmcnt(4)
  buffer_load_dwordx4 v[80:83], v2, s[32:35], s44 offen offset:256 nt
  s_add_u32 s44, s44, 393216
  v_mov_b32_dpp v40, v38 row_newbcast:1 row_mask:0xf bank_mask:0x3
  s_nop 1
  v_mov_b32_dpp v40, v38 row_newbcast:9 row_mask:0xf bank_mask:0xc
  v_and_b32 v8, v40, v4
  v_and_b32 v9, v40, v5
  v_and_b32 v10, v40, v6
  v_and_b32 v11, v40, v7
  s_nop 1
  v_mfma_f32_16x16x32_bf16 v[24:27], v[8:11], v[60:63], v[24:27]
  s_waitcnt vmcnt(4)
  buffer_load_dwordx4 v[84:87], v2, s[32:35], s44 offen offset:0 nt
  v_mfma_f32_16x16x32_bf16 v[28:31], v[8:11], v[64:67], v[28:31]
  s_waitcnt vmcnt(4)
  buffer_load_dwordx4 v[88:91], v2, s[32:35], s44 offen offset:128 nt
  v_mfma_f32_16x16x32_bf16 v[32:35], v[8:11], v[68:71], v[32:35]
  s_waitcnt vmcnt(4)
  buffer_load_dwordx4 v[92:95], v2, s[32:35], s44 offen offset:256 nt
  s_add_u32 s44, s44, 393216
  v_mov_b32_dpp v40, v38 row_newbcast:2 row_mask:0xf bank_mask:0x3
  s_nop 1
  v_mov_b32_dpp v40, v38 row_newbcast:10 row_mask:0xf bank_mask:0xc
  v_and_b32 v8, v40, v4
  v_and_b32 v9, v40, v5
  v_and_b32 v10, v40, v6
  v_and_b32 v11, v40, v7
  s_nop 1
  v_mfma_f32_16x16x32_bf16 v[24:27], v[8:11], v[72:75], v[24:27]
  s_waitcnt vmcnt(4)
  buffer_load_dwordx4 v[96:99], v2, s[32:35], s44 offen offset:0 nt
  v_mfma_f32_16x16x32_bf16 v[28:31], v[8:11], v[76:79], v[28:31]
  s_waitcnt vmcnt(4)
  buffer_load_dwordx4 v[100:103], v2, s[32:35], s44 offen offset:128 nt
  v_mfma_f32_16x16x32_bf16 v[32:35], v[8:11], v[80:83], v[32:35]
  s_waitcnt vmcnt(4)
  buffer_load_dwordx4 v[104:107], v2, s[32:35], s44 offen offset:256 nt
  s_add_u32 s44, s44, 393216
  v_mov_b32_dpp v40, v38 row_newbcast:3 row_mask:0xf bank_mask:0x3
  s_nop 1
  v_mov_b32_dpp v40, v38 row_newbcast:11 row_mask:0xf bank_mask:0xc
  v_and_b32 v8, v40, v4
  v_and_b32 v9, v40, v5
  v_and_b32 v10, v40, v6
  v_and_b32 v11, v40, v7
  s_nop 1
  v_mfma_f32_16x16x32_bf16 v[24:27], v[8:11], v[84:87], v[24:27]
  s_waitcnt vmcnt(4)
  buffer_load_dwordx4 v[108:111], v2, s[32:35], s44 offen offset:0 nt
  v_mfma_f32_16x16x32_bf16 v[28:31], v[8:11], v[88:91], v[28:31]
  s_waitcnt vmcnt(4)
  buffer_load_dwordx4 v[112:115], v2, s[32:35], s44 offen offset:128 nt
  v_mfma_f32_16x16x32_bf16 v[32:35], v[8:11], v[92:95], v[32:35]
  s_waitcnt vmcnt(4)
  buffer_load_dwordx4 v[116:119], v2, s[32:35], s44 offen offset:256 nt
  s_add_u32 s44, s44, 393216
  ds_read_b32 v233, v232 offset:2052
  v_mov_b32_dpp v40, v38 row_newbcast:4 row_mask:0xf bank_mask:0x3
  s_nop 1
  v_mov_b32_dpp v40, v38 row_newbcast:12 row_mask:0xf bank_mask:0xc
  v_and_b32 v8, v40, v4
  v_and_b32 v9, v40, v5
  v_and_b32 v10, v40, v6
  v_and_b32 v11, v40, v7
  s_nop 1
  v_mfma_f32_16x16x32_bf16 v[24:27], v[8:11], v[96:99], v[24:27]
  s_waitcnt vmcnt(4)
  buffer_load_dwordx4 v[120:123], v2, s[32:35], s44 offen offset:0 nt
  v_mfma_f32_16x16x32_bf16 v[28:31], v[8:11], v[100:103], v[28:31]
  s_waitcnt vmcnt(4)
  buffer_load_dwordx4 v[124:127], v2, s[32:35], s44 offen offset:128 nt
  v_mfma_f32_16x16x32_bf16 v[32:35], v[8:11], v[104:107], v[32:35]
  s_waitcnt vmcnt(4)
  buffer_load_dwordx4 v[128:131], v2, s[32:35], s44 offen offset:256 nt
  s_add_u32 s44, s44, 393216
  v_mov_b32_dpp v40, v38 row_newbcast:5 row_mask:0xf bank_mask:0x3
  s_nop 1
  v_mov_b32_dpp v40, v38 row_newbcast:13 row_mask:0xf bank_mask:0xc
  v_and_b32 v8, v40, v4
  v_and_b32 v9, v40, v5
  v_and_b32 v10, v40, v6
  v_and_b32 v11, v40, v7
  s_nop 1
  v_mfma_f32_16x16x32_bf16 v[24:27], v[8:11], v[108:111], v[24:27]
  s_waitcnt vmcnt(4)
  buffer_load_dwordx4 v[132:135], v2, s[32:35], s44 offen offset:0 nt
  v_mfma_f32_16x16x32_bf16 v[28:31], v[8:11], v[112:115], v[28:31]
  s_waitcnt vmcnt(4)
  buffer_load_dwordx4 v[136:139], v2, s[32:35], s44 offen offset:128 nt
  v_mfma_f32_16x16x32_bf16 v[32:35], v[8:11], v[116:119], v[32:35]
  s_waitcnt vmcnt(4)
  buffer_load_dwordx4 v[140:143], v2, s[32:35], s44 offen offset:256 nt
  s_add_u32 s44, s44, 393216
  v_mov_b32_dpp v40, v38 row_newbcast:6 row_mask:0xf bank_mask:0x3
  s_nop 1
  v_mov_b32_dpp v40, v38 row_newbcast:14 row_mask:0xf bank_mask:0xc
  v_and_b32 v8, v40, v4
  v_and_b32 v9, v40, v5
  v_and_b32 v10, v40, v6
  v_and_b32 v11, v40, v7
  s_nop 1
  v_mfma_f32_16x16x32_bf16 v[24:27], v[8:11], v[120:123], v[24:27]
  s_waitcnt vmcnt(4)
  s_cmp_eq_u32 s45, 3
  s_nop 5
  s_cbranch_scc0 L_nosw17
  s_add_u32 s57, s46, 8
  s_mul_i32 s57, s57, 12582912
  s_add_u32 s32, s6, s57
  s_addc_u32 s33, s7, 0
  s_mul_i32 s44, s47, 3072
  s_cmp_eq_u32 s48, 3
  s_cselect_b32 s34, 0, 12582912
  s_cselect_b32 s32, s6, s32
  s_cselect_b32 s33, s7, s33
L_nosw17:
  buffer_load_dwordx4 v[48:51], v2, s[32:35], s44 offen offset:0 nt
  v_mfma_f32_16x16x32_bf16 v[28:31], v[8:11], v[124:127], v[28:31]
  s_waitcnt vmcnt(4)
  buffer_load_dwordx4 v[52:55], v2, s[32:35], s44 offen offset:128 nt
  v_mfma_f32_16x16x32_bf16 v[32:35], v[8:11], v[128:131], v[32:35]
  s_waitcnt vmcnt(4)
  buffer_load_dwordx4 v[56:59], v2, s[32:35], s44 offen offset:256 nt
  s_add_u32 s44, s44, 393216
  v_mov_b32_dpp v40, v38 row_newbcast:7 row_mask:0xf bank_mask:0x3
  s_nop 1
  v_mov_b32_dpp v40, v38 row_newbcast:15 row_mask:0xf bank_mask:0xc
  v_and_b32 v8, v40, v4
  v_and_b32 v9, v40, v5
  v_and_b32 v10, v40, v6
  v_and_b32 v11, v40, v7
  s_nop 1
  v_mfma_f32_16x16x32_bf16 v[24:27], v[8:11], v[132:135], v[24:27]
  s_waitcnt vmcnt(4)
  buffer_load_dwordx4 v[60:63], v2, s[32:35], s44 offen offset:0 nt
  v_mfma_f32_16x16x32_bf16 v[28:31], v[8:11], v[136:139], v[28:31]
  s_waitcnt vmcnt(4)
  buffer_load_dwordx4 v[64:67], v2, s[32:35], s44 offen offset:128 nt
  v_mfma_f32_16x16x32_bf16 v[32:35], v[8:11], v[140:143], v[32:35]
  s_mov_b32 s97, 0
  s_nop 6
  s_branch L_vnext
L_vboost:
  s_cmp_eq_u32 s97, 0
  s_cbranch_scc0 L_vb0
  buffer_load_dwordx4 v[68:71], v2, s[32:35], s44 offen offset:256 nt
  s_add_u32 s44, s44, 393216
  buffer_load_dwordx4 v[72:75], v2, s[32:35], s44 offen offset:0 nt
L_vb0:
  s_waitcnt vmcnt(6)
  buffer_load_dwordx4 v[76:79], v2, s[32:35], s44 offen offset:128 nt
  v_mov_b32_dpp v40, v38 row_newbcast:0 row_mask:0xf bank_mask:0x3
  s_nop 1
  v_mov_b32_dpp v40, v38 row_newbcast:8 row_mask:0xf bank_mask:0xc
  v_and_b32 v8, v40, v4
  v_and_b32 v9, v40, v5
  v_and_b32 v10, v40, v6
  v_and_b32 v11, v40, v7
  s_nop 1
  v_mfma_f32_16x16x32_bf16 v[24:27], v[8:11], v[48:51], v[24:27]
  s_waitcnt vmcnt(6)
  buffer_load_dwordx4 v[80:83], v2, s[32:35], s44 offen offset:256 nt
  s_add_u32 s44, s44, 393216
  v_mfma_f32_16x16x32_bf16 v[28:31], v[8:11], v[52:55], v[28:31]
  s_waitcnt vmcnt(6)
  buffer_load_dwordx4 v[84:87], v2, s[32:35], s44 offen offset:0 nt
  v_mfma_f32_16x16x32_bf16 v[32:35], v[8:11], v[56:59], v[32:35]
  s_waitcnt vmcnt(6)
  buffer_load_dwordx4 v[88:91], v2, s[32:35], s44 offen offset:128 nt
  v_mov_b32_dpp v40, v38 row_newbcast:1 row_mask:0xf bank_mask:0x3
  s_nop 1
  v_mov_b32_dpp v40, v38 row_newbcast:9 row_mask:0xf bank_mask:0xc
  v_and_b32 v8, v40, v4
  v_and_b32 v9, v40, v5
  v_and_b32 v10, v40, v6
  v_and_b32 v11, v40, v7
  s_nop 1
  v_mfma_f32_16x16x32_bf16 v[24:27], v[8:11], v[60:63], v[24:27]
  s_waitcnt vmcnt(6)
  buffer_load_dwordx4 v[92:95], v2, s[32:35], s44 offen offset:256 nt
  s_add_u32 s44, s44, 393216
  v_mfma_f32_16x16x32_bf16 v[28:31], v[8:11], v[64:67], v[28:31]
  s_waitcnt vmcnt(6)
  buffer_load_dwordx4 v[96:99], v2, s[32:35], s44 offen offset:0 nt
  v_mfma_f32_16x16x32_bf16 v[32:35], v[8:11], v[68:71], v[32:35]
  s_waitcnt vmcnt(6)
  buffer_load_dwordx4 v[100:103], v2, s[32:35], s44 offen offset:128 nt
  v_mov_b32_dpp v40, v38 row_newbcast:2 row_mask:0xf bank_mask:0x3
  s_nop 1
  v_mov_b32_dpp v40, v38 row_newbcast:10 row_mask:0xf bank_mask:0xc
  v_and_b32 v8, v40, v4
  v_and_b32 v9, v40, v5
  v_and_b32 v10, v40, v6
  v_and_b32 v11, v40, v7
  s_nop 1
  v_mfma_f32_16x16x32_bf16 v[24:27], v[8:11], v[72:75], v[24:27]
  s_waitcnt vmcnt(6)
  buffer_load_dwordx4 v[104:107], v2, s[32:35], s44 offen offset:256 nt
  s_add_u32 s44, s44, 393216
  v_mfma_f32_16x16x32_bf16 v[28:31], v[8:11], v[76:79], v[28:31]
  s_waitcnt vmcnt(6)
  buffer_load_dwordx4 v[108:111], v2, s[32:35], s44 offen offset:0 nt
  v_mfma_f32_16x16x32_bf16 v[32:35], v[8:11], v[80:83], v[32:35]
  s_waitcnt vmcnt(6)
  buffer_load_dwordx4 v[112:115], v2, s[32:35], s44 offen offset:128 nt
  v_mov_b32_dpp v40, v38 row_newbcast:3 row_mask:0xf bank_mask:0x3
  s_nop 1
  v_mov_b32_dpp v40, v38 row_newbcast:11 row_mask:0xf bank_mask:0xc
  v_and_b32 v8, v40, v4
  v_and_b32 v9, v40, v5
  v_and_b32 v10, v40, v6
  v_and_b32 v11, v40, v7
  s_nop 1
  v_mfma_f32_16x16x32_bf16 v[24:27], v[8:11], v[84:87], v[24:27]
  s_waitcnt vmcnt(6)
  buffer_load_dwordx4 v[116:119], v2, s[32:35], s44 offen offset:256 nt
  s_add_u32 s44, s44, 393216
  v_mfma_f32_16x16x32_bf16 v[28:31], v[8:11], v[88:91], v[28:31]
  s_waitcnt vmcnt(6)
  buffer_load_dwordx4 v[120:123], v2, s[32:35], s44 offen offset:0 nt
  v_mfma_f32_16x16x32_bf16 v[32:35], v[8:11], v[92:95], v[32:35]
  s_waitcnt vmcnt(6)
  buffer_load_dwordx4 v[124:127], v2, s[32:35], s44 offen offset:128 nt
  ds_read_b32 v233, v232 offset:2052
  v_mov_b32_dpp v40, v38 row_newbcast:4 row_mask:0xf bank_mask:0x3
  s_nop 1
  v_mov_b32_dpp v40, v38 row_newbcast:12 row_mask:0xf bank_mask:0xc
  v_and_b32 v8, v40, v4
  v_and_b32 v9, v40, v5
  v_and_b32 v10, v40, v6
  v_and_b32 v11, v40, v7
  s_nop 1
  v_mfma_f32_16x16x32_bf16 v[24:27], v[8:11], v[96:99], v[24:27]
  s_waitcnt vmcnt(6)
  buffer_load_dwordx4 v[128:131], v2, s[32:35], s44 offen offset:256 nt
  s_add_u32 s44, s44, 393216
  v_mfma_f32_16x16x32_bf16 v[28:31], v[8:11], v[100:103], v[28:31]
  s_waitcnt vmcnt(6)
  buffer_load_dwordx4 v[132:135], v2, s[32:35], s44 offen offset:0 nt
  v_mfma_f32_16x16x32_bf16 v[32:35], v[8:11], v[104:107], v[32:35]
  s_waitcnt vmcnt(6)
  buffer_load_dwordx4 v[136:139], v2, s[32:35], s44 offen offset:128 nt
  v_mov_b32_dpp v40, v38 row_newbcast:5 row_mask:0xf bank_mask:0x3
  s_nop 1
  v_mov_b32_dpp v40, v38 row_newbcast:13 row_mask:0xf bank_mask:0xc
  v_and_b32 v8, v40, v4
  v_and_b32 v9, v40, v5
  v_and_b32 v10, v40, v6
  v_and_b32 v11, v40, v7
  s_nop 1
  v_mfma_f32_16x16x32_bf16 v[24:27], v[8:11], v[108:111], v[24:27]
  s_waitcnt vmcnt(6)
  buffer_load_dwordx4 v[140:143], v2, s[32:35], s44 offen offset:256 nt
  s_add_u32 s44, s44, 393216
  v_mfma_f32_16x16x32_bf16 v[28:31], v[8:11], v[112:115], v[28:31]
  s_waitcnt vmcnt(6)
  s_cmp_eq_u32 s45, 3
  s_nop 5
  s_cbranch_scc0 L_nosw18
  s_add_u32 s57, s46, 8
  s_mul_i32 s57, s57, 12582912
  s_add_u32 s32, s6, s57
  s_addc_u32 s33, s7, 0
  s_mul_i32 s44, s47, 3072
  s_cmp_eq_u32 s48, 3
  s_cselect_b32 s34, 0, 12582912
  s_cselect_b32 s32, s6, s32
  s_cselect_b32 s33, s7, s33
L_nosw18:
  buffer_load_dwordx4 v[48:51], v2, s[32:35], s44 offen offset:0 nt
  v_mfma_f32_16x16x32_bf16 v[32:35], v[8:11], v[116:119], v[32:35]
  s_waitcnt vmcnt(6)
  buffer_load_dwordx4 v[52:55], v2, s[32:35], s44 offen offset:128 nt
  v_mov_b32_dpp v40, v38 row_newbcast:6 row_mask:0xf bank_mask:0x3
  s_nop 1
  v_mov_b32_dpp v40, v38 row_newbcast:14 row_mask:0xf bank_mask:0xc
  v_and_b32 v8, v40, v4
  v_and_b32 v9, v40, v5
  v_and_b32 v10, v40, v6
  v_and_b32 v11, v40, v7
  s_nop 1
  v_mfma_f32_16x16x32_bf16 v[24:27], v[8:11], v[120:123], v[24:27]
  s_waitcnt vmcnt(6)
  buffer_load_dwordx4 v[56:59], v2, s[32:35], s44 offen offset:256 nt
  s_add_u32 s44, s44, 393216
  v_mfma_f32_16x16x32_bf16 v[28:31], v[8:11], v[124:127], v[28:31]
  s_waitcnt vmcnt(6)
  buffer_load_dwordx4 v[60:63], v2, s[32:35], s44 offen offset:0 nt
  v_mfma_f32_16x16x32_bf16 v[32:35], v[8:11], v[128:131], v[32:35]
  s_waitcnt vmcnt(6)
  buffer_load_dwordx4 v[64:67], v2, s[32:35], s44 offen offset:128 nt
  v_mov_b32_dpp v40, v38 row_newbcast:7 row_mask:0xf bank_mask:0x3
  s_nop 1
  v_mov_b32_dpp v40, v38 row_newbcast:15 row_mask:0xf bank_mask:0xc
  v_and_b32 v8, v40, v4
  v_and_b32 v9, v40, v5
  v_and_b32 v10, v40, v6
  v_and_b32 v11, v40, v7
  s_nop 1
  v_mfma_f32_16x16x32_bf16 v[24:27], v[8:11], v[132:135], v[24:27]
  s_waitcnt vmcnt(6)
  buffer_load_dwordx4 v[68:71], v2, s[32:35], s44 offen offset:256 nt
  s_add_u32 s44, s44, 393216
  v_mfma_f32_16x16x32_bf16 v[28:31], v[8:11], v[136:139], v[28:31]
  s_waitcnt vmcnt(6)
  buffer_load_dwordx4 v[72:75], v2, s[32:35], s44 offen offset:0 nt
  v_mfma_f32_16x16x32_bf16 v[32:35], v[8:11], v[140:143], v[32:35]
  s_mov_b32 s97, 1
  s_nop 6
L_vnext:
  s_add_u32 s98, s98, 1
  s_cmp_lg_u32 s3, 0
  s_cbranch_scc1 L_pg19
  v_mov_b32 v46, s98
  ds_write_b32 v232, v46 offset:2048
  s_nop 0
L_pg19:
  s_add_u32 s45, s45, 1
  s_cmp_lt_u32 s45, 4
  s_cbranch_scc1 L_vloop
  v_mul_f32 v24, v24, v225
  v_mul_f32 v25, v25, v225
  v_mul_f32 v26, v26, v225
  v_mul_f32 v27, v27, v225
  v_mul_f32 v28, v28, v225
  v_mul_f32 v29, v29, v225
  v_mul_f32 v30, v30, v225
  v_mul_f32 v31, v31, v225
  v_mul_f32 v32, v32, v225
  v_mul_f32 v33, v33, v225
  v_mul_f32 v34, v34, v225
  v_mul_f32 v35, v35, v225
  s_cmp_eq_u32 s48, 3
  s_nop 0
  s_cbranch_scc1 L_lastphase
  s_cmp_eq_u32 s97, 1
  s_cbranch_scc1 L_dp20
  buffer_load_dwordx4 v[68:71], v2, s[32:35], s44 offen offset:256 nt
  s_add_u32 s44, s44, 393216
  buffer_load_dwordx4 v[72:75], v2, s[32:35], s44 offen offset:0 nt
  s_mov_b32 s97, 1
L_dp20:
  s_mov_b32 s81, 524288
L_lw21:
  ds_read_b32 v42, v232 offset:2060
  s_waitcnt lgkmcnt(0)
  v_readfirstlane_b32 s57, v42
  s_cmp_ge_u32 s57, s48
  s_nop 3
  s_cbranch_scc1 L_lk21
  s_sub_u32 s81, s81, 1
  s_cmp_eq_u32 s81, 0
  s_cbranch_scc1 L_abort
  s_branch L_lw21
L_lk21:
  s_mov_b32 exec_lo, 0x00FF00FF
  s_mov_b32 exec_hi, 0xFF00FF00
  ds_write_b128 v226, v[24:27] offset:41984
  ds_write_b128 v226, v[28:31] offset:42240
  ds_write_b128 v226, v[32:35] offset:42496
  s_mov_b64 exec, -1
  s_add_u32 s48, s48, 1
  s_add_u32 s46, s46, 8
  s_lshl_b32 s58, s3, 2
  v_mov_b32 v43, s58
  v_mov_b32 v44, s48
  s_waitcnt lgkmcnt(0)
  ds_write_b32 v43, v44 offset:2064
  s_add_u32 s59, s48, 1
  s_mov_b32 s81, 524288
L_lw22:
  ds_read_b32 v42, v232 offset:2080
  s_waitcnt lgkmcnt(0)
  v_readfirstlane_b32 s57, v42
  s_cmp_ge_u32 s57, s59
  s_nop 3
  s_cbranch_scc1 L_lk22
  s_sub_u32 s81, s81, 1
  s_cmp_eq_u32 s81, 0
  s_cbranch_scc1 L_abort
  s_branch L_lw22
L_lk22:
  v_and_b32 v41, 7, v1
  v_lshlrev_b32 v41, 4, v41
  s_mul_i32 s57, s48, 384
  v_add_u32 v41, s57, v41
  ds_read_b128 v[12:15], v41 offset:5120
  ds_read_b128 v[16:19], v41 offset:5248
  ds_read_b128 v[20:23], v41 offset:5376
  v_lshlrev_b32 v47, 2, v1
  s_lshl_b32 s57, s3, 12
  v_add_u32 v47, s57, v47
  v_mov_b32 v37, 0xff800000
  v_mov_b32 v224, 0
  s_waitcnt lgkmcnt(0)
  s_mov_b32 s45, 0
  s_branch L_kloop
L_lastphase:
  s_mov_b32 exec_lo, 0x00FF00FF
  s_mov_b32 exec_hi, 0xFF00FF00
  ds_write_b128 v226, v[24:27] offset:6656
  ds_write_b128 v226, v[28:31] offset:6912
  ds_write_b128 v226, v[32:35] offset:7168
  s_mov_b64 exec, -1
  s_waitcnt lgkmcnt(0)
  s_barrier
  s_cmp_lg_u32 s3, 0
  s_cbranch_scc1 L_pubdone
  v_lshlrev_b32 v41, 4, v1
  s_mov_b32 exec_lo, 0xffffffff
  s_mov_b32 exec_hi, 0x0000ffff
  ds_read_b128 v[84:87], v41 offset:6656
  ds_read_b128 v[88:91], v41 offset:7424
  ds_read_b128 v[92:95], v41 offset:8192
  ds_read_b128 v[96:99], v41 offset:8960
  ds_read_b128 v[100:103], v41 offset:9728
  ds_read_b128 v[104:107], v41 offset:10496
  ds_read_b128 v[108:111], v41 offset:11264
  ds_read_b128 v[112:115], v41 offset:12032
  s_waitcnt lgkmcnt(4)
  v_pk_add_f32 v[84:85], v[84:85], v[88:89]
  v_pk_add_f32 v[86:87], v[86:87], v[90:91]
  v_pk_add_f32 v[84:85], v[84:85], v[92:93]
  v_pk_add_f32 v[86:87], v[86:87], v[94:95]
  v_pk_add_f32 v[84:85], v[84:85], v[96:97]
  v_pk_add_f32 v[86:87], v[86:87], v[98:99]
  s_waitcnt lgkmcnt(0)
  v_pk_add_f32 v[100:101], v[100:101], v[104:105]
  v_pk_add_f32 v[102:103], v[102:103], v[106:107]
  v_pk_add_f32 v[100:101], v[100:101], v[108:109]
  v_pk_add_f32 v[102:103], v[102:103], v[110:111]
  v_pk_add_f32 v[100:101], v[100:101], v[112:113]
  v_pk_add_f32 v[102:103], v[102:103], v[114:115]
  v_pk_add_f32 v[84:85], v[84:85], v[100:101]
  v_pk_add_f32 v[86:87], v[86:87], v[102:103]
  v_perm_b32 v84, v84, v3, s52
  v_perm_b32 v85, v85, v3, s53
  v_perm_b32 v86, v86, v3, s54
  v_perm_b32 v87, v87, v3, s55
  s_cmp_eq_u32 s30, 1
  s_nop 0
  s_cbranch_scc1 L_pl23
  buffer_store_dwordx4 v[84:87], v227, s[36:39], s87 offen sc1
  s_nop 1
  s_branch L_pd23
L_pl23:
  buffer_store_dwordx4 v[84:87], v227, s[36:39], s87 offen
  s_nop 1
L_pd23:
  s_and_b32 s57, s49, 0xffffff00
  s_or_b32 s57, s57, 255
  v_mov_b32 v42, s57
  s_and_b32 s57, s2, 7
  s_lshl_b32 s57, s57, 7
  s_lshr_b32 s58, s2, 3
  s_lshl_b32 s58, s58, 2
  s_add_u32 s57, s57, s58
  s_add_u32 s57, s57, 1839104
  s_mov_b64 exec, 1
  buffer_store_dword v42, v232, s[36:39], s57 offen
  s_mov_b64 exec, -1
L_pubdone:
L_tail:
  s_cmp_eq_u32 s50, 1
  s_cbranch_scc1 L_roleF
  s_cmp_eq_u32 s50, 2
  s_cbranch_scc1 L_roleR
  s_mul_i32 s57, s99, 6144
  s_add_u32 s86, s57, 393216
  s_mul_i32 s58, s3, 48
  s_add_u32 s86, s86, s58
  v_lshrrev_b32 v44, 2, v1
  v_and_b32 v44, 15, v44
  v_mul_u32_u24 v44, 192, v44
  v_and_b32 v45, 3, v1
  v_min_u32 v45, 2, v45
  v_lshlrev_b32 v45, 4, v45
  v_add_u32 v44, v44, v45
  s_mov_b32 s81, 524288
  buffer_load_dwordx4 v[120:123], v44, s[36:39], s86 offen offset:0 sc1
  buffer_load_dwordx4 v[124:127], v44, s[36:39], s86 offen offset:3072 sc1
  s_waitcnt vmcnt(0)
  s_branch L_pollchk24
L_poll24:
  s_sub_u32 s81, s81, 1
  s_cmp_eq_u32 s81, 0
  s_cbranch_scc1 L_abort
  buffer_load_dwordx4 v[120:123], v44, s[36:39], s86 offen offset:0 sc1
  buffer_load_dwordx4 v[124:127], v44, s[36:39], s86 offen offset:3072 sc1
  s_waitcnt vmcnt(0)
L_pollchk24:
  v_perm_b32 v41, v121, v120, s56
  v_perm_b32 v42, v123, v122, s56
  v_lshl_or_b32 v41, v42, 16, v41
  v_cmp_ne_u32 vcc, v41, v3
  s_mov_b64 s[84:85], vcc
  v_perm_b32 v41, v125, v124, s56
  v_perm_b32 v42, v127, v126, s56
  v_lshl_or_b32 v41, v42, 16, v41
  v_cmp_ne_u32 vcc, v41, v3
  s_or_b64 s[84:85], s[84:85], vcc
  s_cmp_lg_u64 s[84:85], 0
  s_nop 2
  s_cbranch_scc1 L_poll24
  v_and_b32 v120, 0xffffff00, v120
  v_and_b32 v121, 0xffffff00, v121
  v_and_b32 v122, 0xffffff00, v122
  v_and_b32 v123, 0xffffff00, v123
  v_and_b32 v124, 0xffffff00, v124
  v_and_b32 v125, 0xffffff00, v125
  v_and_b32 v126, 0xffffff00, v126
  v_and_b32 v127, 0xffffff00, v127
  v_pk_add_f32 v[108:109], v[120:121], v[124:125]
  v_pk_add_f32 v[110:111], v[122:123], v[126:127]
  s_nop 0
  v_add_f32_dpp v108, v108, v108 row_ror:4 row_mask:0xf bank_mask:0xf
  v_add_f32_dpp v109, v109, v109 row_ror:4 row_mask:0xf bank_mask:0xf
  v_add_f32_dpp v110, v110, v110 row_ror:4 row_mask:0xf bank_mask:0xf
  v_add_f32_dpp v111, v111, v111 row_ror:4 row_mask:0xf bank_mask:0xf
  v_add_f32_dpp v108, v108, v108 row_ror:8 row_mask:0xf bank_mask:0xf
  v_add_f32_dpp v109, v109, v109 row_ror:8 row_mask:0xf bank_mask:0xf
  v_add_f32_dpp v110, v110, v110 row_ror:8 row_mask:0xf bank_mask:0xf
  v_add_f32_dpp v111, v111, v111 row_ror:8 row_mask:0xf bank_mask:0xf
  v_mov_b32 v41, v108
  v_mov_b32 v42, v109
  v_mov_b32 v43, v110
  v_mov_b32 v44, v111
  v_permlane16_swap_b32 v41, v108
  v_permlane16_swap_b32 v42, v109
  v_permlane16_swap_b32 v43, v110
  v_permlane16_swap_b32 v44, v111
  v_add_f32 v108, v108, v41
  v_add_f32 v109, v109, v42
  v_add_f32 v110, v110, v43
  v_add_f32 v111, v111, v44
  v_mov_b32 v41, v108
  v_mov_b32 v42, v109
  v_mov_b32 v43, v110
  v_mov_b32 v44, v111
  v_permlane32_swap_b32 v41, v108
  v_permlane32_swap_b32 v42, v109
  v_permlane32_swap_b32 v43, v110
  v_permlane32_swap_b32 v44, v111
  v_add_f32 v108, v108, v41
  v_add_f32 v109, v109, v42
  v_add_f32 v110, v110, v43
  v_add_f32 v111, v111, v44
  v_cndmask_b32 v108, v108, v109, s[90:91]
  v_cndmask_b32 v108, v108, v110, s[92:93]
  v_cndmask_b32 v108, v108, v111, s[94:95]
  v_cvt_pk_bf16_f32 v108, v108, v108
  s_nop 1
  v_mov_b32_dpp v116, v108 quad_perm:[0,0,0,0] row_mask:0xf bank_mask:0xf
  v_mov_b32_dpp v117, v108 quad_perm:[1,1,1,1] row_mask:0xf bank_mask:0xf
  v_mov_b32_dpp v118, v108 quad_perm:[2,2,2,2] row_mask:0xf bank_mask:0xf
  v_and_b32 v8, v116, v4
  v_and_b32 v9, v116, v5
  v_and_b32 v10, v116, v6
  v_and_b32 v11, v116, v7
  s_nop 1
  v_mfma_f32_16x16x32_bf16 v[204:207], v[8:11], v[144:147], v[204:207]
  v_mfma_f32_16x16x32_bf16 v[208:211], v[8:11], v[148:151], v[208:211]
  v_mfma_f32_16x16x32_bf16 v[212:215], v[8:11], v[152:155], v[212:215]
  v_mfma_f32_16x16x32_bf16 v[216:219], v[8:11], v[156:159], v[216:219]
  v_mfma_f32_16x16x32_bf16 v[220:223], v[8:11], v[160:163], v[220:223]
  v_and_b32 v8, v117, v4
  v_and_b32 v9, v117, v5
  v_and_b32 v10, v117, v6
  v_and_b32 v11, v117, v7
  s_nop 1
  v_mfma_f32_16x16x32_bf16 v[204:207], v[8:11], v[164:167], v[204:207]
  v_mfma_f32_16x16x32_bf16 v[208:211], v[8:11], v[168:171], v[208:211]
  v_mfma_f32_16x16x32_bf16 v[212:215], v[8:11], v[172:175], v[212:215]
  v_mfma_f32_16x16x32_bf16 v[216:219], v[8:11], v[176:179], v[216:219]
  v_mfma_f32_16x16x32_bf16 v[220:223], v[8:11], v[180:183], v[220:223]
  v_and_b32 v8, v118, v4
  v_and_b32 v9, v118, v5
  v_and_b32 v10, v118, v6
  v_and_b32 v11, v118, v7
  s_nop 1
  v_mfma_f32_16x16x32_bf16 v[204:207], v[8:11], v[184:187], v[204:207]
  v_mfma_f32_16x16x32_bf16 v[208:211], v[8:11], v[188:191], v[208:211]
  v_mfma_f32_16x16x32_bf16 v[212:215], v[8:11], v[192:195], v[212:215]
  v_mfma_f32_16x16x32_bf16 v[216:219], v[8:11], v[196:199], v[216:219]
  v_mfma_f32_16x16x32_bf16 v[220:223], v[8:11], v[200:203], v[220:223]
  s_mov_b32 exec_lo, 0x00FF00FF
  s_mov_b32 exec_hi, 0xFF00FF00
  s_nop 1
  ds_write_b128 v12, v[204:207] offset:12800
  ds_write_b128 v12, v[208:211] offset:13312
  ds_write_b128 v12, v[212:215] offset:13824
  ds_write_b128 v12, v[216:219] offset:14336
  ds_write_b128 v12, v[220:223] offset:14848
  s_mov_b64 exec, -1
  v_lshlrev_b32 v41, 4, v0
  s_lshl_b32 s57, s51, 7
  s_add_u32 s57, s57, 1245184
  s_waitcnt lgkmcnt(0)
  s_barrier
  v_cmp_gt_u32 vcc, 160, v0
  s_and_saveexec_b64 s[82:83], vcc
  s_nop 3
  s_cbranch_execz L_rpd25
  ds_read_b128 v[204:207], v41 offset:12800
  ds_read_b128 v[208:211], v41 offset:15360
  ds_read_b128 v[212:215], v41 offset:17920
  ds_read_b128 v[216:219], v41 offset:20480
  s_waitcnt lgkmcnt(0)
  v_pk_add_f32 v[204:205], v[204:205], v[208:209]
  v_pk_add_f32 v[206:207], v[206:207], v[210:211]
  v_pk_add_f32 v[212:213], v[212:213], v[216:217]
  v_pk_add_f32 v[214:215], v[214:215], v[218:219]
  v_pk_add_f32 v[204:205], v[204:205], v[212:213]
  v_pk_add_f32 v[206:207], v[206:207], v[214:215]
  v_perm_b32 v204, v204, v3, s52
  v_perm_b32 v205, v205, v3, s53
  v_perm_b32 v206, v206, v3, s54
  v_perm_b32 v207, v207, v3, s55
  buffer_store_dwordx4 v[204:207], v13, s[36:39], s57 offen sc1
  s_nop 1
L_rpd25:
  s_mov_b64 exec, s[82:83]
  s_branch L_end
L_roleF:
  s_and_b32 s57, s49, 0xffffff00
  s_or_b32 s57, s57, 255
  v_mov_b32 v42, s57
  s_and_b32 s57, s2, 7
  s_lshl_b32 s57, s57, 7
  s_add_u32 s57, s57, 1839104
  v_and_b32 v41, 31, v1
  v_lshlrev_b32 v41, 2, v41
  s_mov_b32 s81, 64
  s_nop 0
L_cw26:
  buffer_load_dword v43, v41, s[36:39], s57 offen sc1
  s_sub_u32 s81, s81, 1
  s_cmp_eq_u32 s81, 0
  s_cbranch_scc1 L_cwd26
  s_waitcnt vmcnt(0)
  v_cmp_ne_u32 vcc, v43, v42
  s_nop 4
  s_cbranch_vccnz L_cw26
L_cwd26:
  s_waitcnt vmcnt(0)
  v_min_u32 v46, 39, v1
  s_mul_i32 s57, s3, 40
  v_add_u32 v46, s57, v46
  v_lshlrev_b32 v46, 4, v46
  s_and_b32 s86, s2, 7
  s_lshl_b32 s86, s86, 12
  s_add_u32 s86, s86, 1900544
  s_mov_b32 s81, 524288
  buffer_load_dwordx4 v[108:111], v46, s[36:39], s86 offen sc1
  s_lshl_b32 s57, s3, 12
  s_add_u32 s57, s57, 25088
  v_lshlrev_b32 v130, 6, v1
  v_add_u32 v130, s57, v130
  v_mov_b32 v41, 0
  v_mov_b32 v42, s57
  ds_write_b32 v42, v41 offset:2560
  v_lshrrev_b32 v131, 2, v1
  v_lshlrev_b32 v131, 4, v131
  v_and_b32 v41, 3, v1
  v_mov_b32 v42, 0x08000c04
  v_lshlrev_b32 v41, 3, v41
  v_lshrrev_b32 v42, v41, v42
  v_and_b32 v42, 0xff, v42
  v_add3_u32 v131, v131, v42, s57
  v_add_u32 v132, 1024, v131
  v_add_u32 v133, 2048, v131
  v_lshrrev_b32 v41, 4, v1
  s_lshl_b32 s57, s3, 2
  v_add_u32 v41, s57, v41
  v_lshlrev_b32 v41, 7, v41
  v_and_b32 v42, 3, v1
  v_lshlrev_b32 v42, 5, v42
  v_add_u32 v134, v41, v42
  v_and_b32 v41, 31, v1
  v_lshlrev_b32 v41, 2, v41
  v_lshrrev_b32 v42, 5, v1
  v_lshlrev_b32 v42, 10, v42
  v_add_u32 v135, v41, v42
  v_lshrrev_b32 v41, 4, v1
  s_lshl_b32 s57, s3, 2
  v_add_u32 v41, s57, v41
  v_lshlrev_b32 v136, 2, v41
  v_mov_b32 v24, 0
  v_mov_b32 v25, 0
  v_mov_b32 v26, 0
  v_mov_b32 v27, 0
  v_mov_b32 v28, 0
  v_mov_b32 v29, 0
  v_mov_b32 v30, 0
  v_mov_b32 v31, 0
  v_mov_b32 v137, 0x3f803f80
  v_cmp_gt_u32 s[82:83], 40, v1
  s_lshl_b32 s57, s3, 3
  v_mov_b32 v126, s57
  s_waitcnt vmcnt(0)
  s_nop 1
  s_branch L_pollchk27
L_poll27:
  s_sub_u32 s81, s81, 1
  s_cmp_eq_u32 s81, 0
  s_cbranch_scc1 L_abort
  buffer_load_dwordx4 v[108:111], v46, s[36:39], s86 offen sc1
  s_waitcnt vmcnt(0)
L_pollchk27:
  v_perm_b32 v41, v109, v108, s56
  v_perm_b32 v42, v111, v110, s56
  v_lshl_or_b32 v41, v42, 16, v41
  v_cmp_ne_u32 vcc, v41, v3
  s_mov_b64 s[84:85], vcc
  s_cmp_lg_u64 s[84:85], 0
  s_nop 2
  s_cbranch_scc1 L_poll27
  v_perm_b32 v124, v109, v108, s96
  v_perm_b32 v125, v111, v110, s96
  v_and_b32 v120, 0xffff0000, v108
  v_and_b32 v121, 0xffff0000, v109
  v_and_b32 v122, 0xffff0000, v110
  v_and_b32 v123, 0xffff0000, v111
  v_cndmask_b32 v124, 0, v124, s[82:83]
  v_cndmask_b32 v125, 0, v125, s[82:83]
  v_dot2_f32_bf16 v41, v124, v137, 0
  v_dot2_f32_bf16 v42, v124, v124, 0
  v_dot2_f32_bf16 v41, v125, v137, v41
  v_dot2_f32_bf16 v42, v125, v125, v42
  s_nop 1
  v_add_f32_dpp v41, v41, v41 quad_perm:[1,0,3,2] row_mask:0xf bank_mask:0xf
  v_add_f32_dpp v42, v42, v42 quad_perm:[1,0,3,2] row_mask:0xf bank_mask:0xf
  s_nop 0
  v_add_f32_dpp v41, v41, v41 quad_perm:[2,3,0,1] row_mask:0xf bank_mask:0xf
  v_add_f32_dpp v42, v42, v42 quad_perm:[2,3,0,1] row_mask:0xf bank_mask:0xf
  s_nop 0
  v_add_f32_dpp v41, v41, v41 row_half_mirror row_mask:0xf bank_mask:0xf
  v_add_f32_dpp v42, v42, v42 row_half_mirror row_mask:0xf bank_mask:0xf
  s_nop 0
  v_add_f32_dpp v41, v41, v41 row_mirror row_mask:0xf bank_mask:0xf
  v_add_f32_dpp v42, v42, v42 row_mirror row_mask:0xf bank_mask:0xf
  v_mov_b32 v43, v41
  v_mov_b32 v44, v42
  s_nop 0
  v_permlane16_swap_b32 v43, v41
  v_permlane16_swap_b32 v44, v42
  v_add_f32 v41, v41, v43
  v_add_f32 v42, v42, v44
  v_mov_b32 v43, v41
  v_mov_b32 v44, v42
  s_nop 0
  v_permlane32_swap_b32 v43, v41
  v_permlane32_swap_b32 v44, v42
  v_add_f32 v41, v41, v43
  v_add_f32 v42, v42, v44
  v_mov_b32 v16, v41
  v_mov_b32 v17, v42
  s_mov_b64 exec, 1
  ds_write_b64 v126, v[16:17] offset:2304
  s_mov_b64 exec, -1
  s_waitcnt lgkmcnt(0)
  s_barrier
  ds_read_b128 v[16:19], v232 offset:2304
  ds_read_b128 v[20:23], v232 offset:2320
  s_waitcnt lgkmcnt(0)
  v_pk_add_f32 v[16:17], v[16:17], v[18:19]
  v_pk_add_f32 v[20:21], v[20:21], v[22:23]
  v_pk_add_f32 v[16:17], v[16:17], v[20:21]
  v_mov_b32 v41, v16
  v_mov_b32 v42, v17
  v_mul_f32 v41, 0x3acccccd, v41
  v_mul_f32 v42, 0x3acccccd, v42
  v_fma_f32 v42, -v41, v41, v42
  v_max_f32 v42, 0, v42
  v_cvt_pk_bf16_f32 v42, v42, v42
  v_lshlrev_b32 v42, 16, v42
  v_add_f32 v42, 0x3727c5ac, v42
  v_cvt_pk_bf16_f32 v42, v42, v42
  v_lshlrev_b32 v42, 16, v42
  v_cvt_pk_bf16_f32 v41, v41, v41
  v_lshlrev_b32 v41, 16, v41
  v_sqrt_f32 v42, v42
  s_nop 0
  v_cvt_pk_bf16_f32 v42, v42, v42
  v_lshlrev_b32 v42, 16, v42
  v_rcp_f32 v45, v42
  v_sub_f32 v120, v120, v41
  v_sub_f32 v121, v121, v41
  v_sub_f32 v122, v122, v41
  v_sub_f32 v123, v123, v41
  v_cvt_pk_bf16_f32 v43, v120, v121
  v_cvt_pk_bf16_f32 v44, v122, v123
  v_lshlrev_b32 v120, 16, v43
  v_and_b32 v121, 0xffff0000, v43
  v_lshlrev_b32 v122, 16, v44
  v_and_b32 v123, 0xffff0000, v44
  v_mul_f32 v120, v120, v45
  v_mul_f32 v121, v121, v45
  v_mul_f32 v122, v122, v45
  v_mul_f32 v123, v123, v45
  v_cvt_pk_bf16_f32 v43, v120, v121
  v_cvt_pk_bf16_f32 v44, v122, v123
  v_mov_b32 v72, 0
  v_mov_b32 v74, 0
  v_and_b32 v73, 0xffff, v43
  v_lshlrev_b32 v75, 16, v43
  v_mov_b32 v76, 0
  v_mov_b32 v78, 0
  v_lshrrev_b32 v77, 16, v43
  v_and_b32 v79, 0xffff0000, v43
  v_mov_b32 v80, 0
  v_mov_b32 v82, 0
  v_and_b32 v81, 0xffff, v44
  v_lshlrev_b32 v83, 16, v44
  v_mov_b32 v84, 0
  v_mov_b32 v86, 0
  v_lshrrev_b32 v85, 16, v44
  v_and_b32 v87, 0xffff0000, v44
  s_mov_b32 exec_lo, 0xffffffff
  s_mov_b32 exec_hi, 0x000000ff
  ds_write_b128 v130, v[72:75] offset:0
  ds_write_b128 v130, v[76:79] offset:16
  ds_write_b128 v130, v[80:83] offset:32
  ds_write_b128 v130, v[84:87] offset:48
  s_mov_b64 exec, -1
  s_waitcnt lgkmcnt(0)
  ds_read2_b32 v[72:73], v131 offset0:0 offset1:1
  ds_read2_b32 v[74:75], v131 offset0:64 offset1:65
  ds_read2_b32 v[76:77], v131 offset0:128 offset1:129
  ds_read2_b32 v[78:79], v131 offset0:192 offset1:193
  ds_read2_b32 v[80:81], v132 offset0:0 offset1:1
  ds_read2_b32 v[82:83], v132 offset0:64 offset1:65
  ds_read2_b32 v[84:85], v132 offset0:128 offset1:129
  ds_read2_b32 v[86:87], v132 offset0:192 offset1:193
  ds_read2_b32 v[88:89], v133 offset0:0 offset1:1
  ds_read2_b32 v[90:91], v133 offset0:64 offset1:65
  s_waitcnt lgkmcnt(9)
  v_mfma_f32_4x4x4_16b_bf16 v[24:27], v[72:73], v[144:145], v[24:27]
  v_mfma_f32_4x4x4_16b_bf16 v[28:31], v[72:73], v[146:147], v[28:31]
  s_waitcnt lgkmcnt(8)
  v_mfma_f32_4x4x4_16b_bf16 v[24:27], v[74:75], v[148:149], v[24:27]
  v_mfma_f32_4x4x4_16b_bf16 v[28:31], v[74:75], v[150:151], v[28:31]
  s_waitcnt lgkmcnt(7)
  v_mfma_f32_4x4x4_16b_bf16 v[24:27], v[76:77], v[152:153], v[24:27]
  v_mfma_f32_4x4x4_16b_bf16 v[28:31], v[76:77], v[154:155], v[28:31]
  s_waitcnt lgkmcnt(6)
  v_mfma_f32_4x4x4_16b_bf16 v[24:27], v[78:79], v[156:157], v[24:27]
  v_mfma_f32_4x4x4_16b_bf16 v[28:31], v[78:79], v[158:159], v[28:31]
  s_waitcnt lgkmcnt(5)
  v_mfma_f32_4x4x4_16b_bf16 v[24:27], v[80:81], v[160:161], v[24:27]
  v_mfma_f32_4x4x4_16b_bf16 v[28:31], v[80:81], v[162:163], v[28:31]
  s_waitcnt lgkmcnt(4)
  v_mfma_f32_4x4x4_16b_bf16 v[24:27], v[82:83], v[164:165], v[24:27]
  v_mfma_f32_4x4x4_16b_bf16 v[28:31], v[82:83], v[166:167], v[28:31]
  s_waitcnt lgkmcnt(3)
  v_mfma_f32_4x4x4_16b_bf16 v[24:27], v[84:85], v[168:169], v[24:27]
  v_mfma_f32_4x4x4_16b_bf16 v[28:31], v[84:85], v[170:171], v[28:31]
  s_waitcnt lgkmcnt(2)
  v_mfma_f32_4x4x4_16b_bf16 v[24:27], v[86:87], v[172:173], v[24:27]
  v_mfma_f32_4x4x4_16b_bf16 v[28:31], v[86:87], v[174:175], v[28:31]
  s_waitcnt lgkmcnt(1)
  v_mfma_f32_4x4x4_16b_bf16 v[24:27], v[88:89], v[176:177], v[24:27]
  v_mfma_f32_4x4x4_16b_bf16 v[28:31], v[88:89], v[178:179], v[28:31]
  s_waitcnt lgkmcnt(0)
  v_mfma_f32_4x4x4_16b_bf16 v[24:27], v[90:91], v[180:181], v[24:27]
  v_mfma_f32_4x4x4_16b_bf16 v[28:31], v[90:91], v[182:183], v[28:31]
  s_nop 3
  v_add_f32_dpp v24, v24, v24 row_ror:4 row_mask:0xf bank_mask:0xf
  v_add_f32_dpp v25, v25, v25 row_ror:4 row_mask:0xf bank_mask:0xf
  v_add_f32_dpp v26, v26, v26 row_ror:4 row_mask:0xf bank_mask:0xf
  v_add_f32_dpp v27, v27, v27 row_ror:4 row_mask:0xf bank_mask:0xf
  v_add_f32_dpp v28, v28, v28 row_ror:4 row_mask:0xf bank_mask:0xf
  v_add_f32_dpp v29, v29, v29 row_ror:4 row_mask:0xf bank_mask:0xf
  v_add_f32_dpp v30, v30, v30 row_ror:4 row_mask:0xf bank_mask:0xf
  v_add_f32_dpp v31, v31, v31 row_ror:4 row_mask:0xf bank_mask:0xf
  v_add_f32_dpp v24, v24, v24 row_ror:8 row_mask:0xf bank_mask:0xf
  v_add_f32_dpp v25, v25, v25 row_ror:8 row_mask:0xf bank_mask:0xf
  v_add_f32_dpp v26, v26, v26 row_ror:8 row_mask:0xf bank_mask:0xf
  v_add_f32_dpp v27, v27, v27 row_ror:8 row_mask:0xf bank_mask:0xf
  v_add_f32_dpp v28, v28, v28 row_ror:8 row_mask:0xf bank_mask:0xf
  v_add_f32_dpp v29, v29, v29 row_ror:8 row_mask:0xf bank_mask:0xf
  v_add_f32_dpp v30, v30, v30 row_ror:8 row_mask:0xf bank_mask:0xf
  v_add_f32_dpp v31, v31, v31 row_ror:8 row_mask:0xf bank_mask:0xf
  s_mov_b32 exec_lo, 0x000f000f
  s_mov_b32 exec_hi, 0x000f000f
  ds_write_b128 v134, v[24:27] offset:23040
  ds_write_b128 v134, v[28:31] offset:23056
  s_mov_b64 exec, -1
  s_waitcnt lgkmcnt(0)
  s_barrier
  ds_read_b32 v72, v135 offset:23040
  ds_read_b32 v73, v135 offset:23168
  ds_read_b32 v74, v135 offset:23296
  ds_read_b32 v75, v135 offset:23424
  ds_read_b32 v76, v135 offset:23552
  ds_read_b32 v77, v135 offset:23680
  ds_read_b32 v78, v135 offset:23808
  ds_read_b32 v79, v135 offset:23936
  s_waitcnt lgkmcnt(0)
  v_pk_add_f32 v[72:73], v[72:73], v[74:75]
  v_pk_add_f32 v[76:77], v[76:77], v[78:79]
  v_pk_add_f32 v[72:73], v[72:73], v[76:77]
  v_add_f32 v72, v72, v73
  v_mov_b32 v41, v72
  s_nop 1
  v_permlane32_swap_b32 v41, v72
  v_add_f32 v72, v72, v41
  v_cvt_pk_bf16_f32 v72, v72, v72
  v_lshlrev_b32 v72, 16, v72
  v_mov_b32 v41, v72
  s_nop 1
  v_permlane16_swap_b32 v41, v72
  v_mul_f32 v42, 0xbfb8aa3b, v41
  v_min_f32 v42, 0x42fc0000, v42
  v_exp_f32 v42, v42
  s_nop 0
  v_add_f32 v42, 1.0, v42
  v_rcp_f32 v43, v42
  s_nop 0
  v_mul_f32 v44, v41, v43
  v_cvt_pk_bf16_f32 v44, v44, v44
  v_lshlrev_b32 v44, 16, v44
  v_mul_f32 v44, v44, v72
  v_cvt_pk_bf16_f32 v44, v44, v44
  ds_bpermute_b32 v73, v136, v44
  s_waitcnt lgkmcnt(0)
  v_and_b32 v8, v73, v4
  v_and_b32 v9, v73, v5
  v_and_b32 v10, v73, v6
  v_and_b32 v11, v73, v7
  s_nop 1
  v_mfma_f32_16x16x32_bf16 v[204:207], v[8:11], v[184:187], v[204:207]
  v_mfma_f32_16x16x32_bf16 v[208:211], v[8:11], v[188:191], v[208:211]
  v_mfma_f32_16x16x32_bf16 v[212:215], v[8:11], v[192:195], v[212:215]
  v_mfma_f32_16x16x32_bf16 v[216:219], v[8:11], v[196:199], v[216:219]
  v_mfma_f32_16x16x32_bf16 v[220:223], v[8:11], v[200:203], v[220:223]
  s_mov_b32 exec_lo, 0x00FF00FF
  s_mov_b32 exec_hi, 0xFF00FF00
  s_nop 1
  ds_write_b128 v12, v[204:207] offset:12800
  ds_write_b128 v12, v[208:211] offset:13312
  ds_write_b128 v12, v[212:215] offset:13824
  ds_write_b128 v12, v[216:219] offset:14336
  ds_write_b128 v12, v[220:223] offset:14848
  s_mov_b64 exec, -1
  v_lshlrev_b32 v41, 4, v0
  s_lshl_b32 s57, s51, 7
  s_add_u32 s57, s57, 1576960
  s_waitcnt lgkmcnt(0)
  s_barrier
  v_cmp_gt_u32 vcc, 160, v0
  s_and_saveexec_b64 s[82:83], vcc
  s_nop 3
  s_cbranch_execz L_rpd28
  ds_read_b128 v[204:207], v41 offset:12800
  ds_read_b128 v[208:211], v41 offset:15360
  ds_read_b128 v[212:215], v41 offset:17920
  ds_read_b128 v[216:219], v41 offset:20480
  s_waitcnt lgkmcnt(0)
  v_pk_add_f32 v[204:205], v[204:205], v[208:209]
  v_pk_add_f32 v[206:207], v[206:207], v[210:211]
  v_pk_add_f32 v[212:213], v[212:213], v[216:217]
  v_pk_add_f32 v[214:215], v[214:215], v[218:219]
  v_pk_add_f32 v[204:205], v[204:205], v[212:213]
  v_pk_add_f32 v[206:207], v[206:207], v[214:215]
  v_perm_b32 v204, v204, v3, s52
  v_perm_b32 v205, v205, v3, s53
  v_perm_b32 v206, v206, v3, s54
  v_perm_b32 v207, v207, v3, s55
  buffer_store_dwordx4 v[204:207], v13, s[36:39], s57 offen sc1
  s_nop 1
L_rpd28:
  s_mov_b64 exec, s[82:83]
  s_branch L_end
L_roleR:
  s_cmp_ge_u32 s51, 20
  s_cbranch_scc1 L_fin
  s_and_b32 s57, s49, 0xffffff00
  s_or_b32 s57, s57, 255
  v_mov_b32 v42, s57
  s_and_b32 s57, s2, 7
  s_lshl_b32 s57, s57, 7
  s_add_u32 s57, s57, 1839104
  v_and_b32 v41, 31, v1
  v_lshlrev_b32 v41, 2, v41
  s_mov_b32 s81, 64
  s_nop 0
L_cw29:
  buffer_load_dword v43, v41, s[36:39], s57 offen sc1
  s_sub_u32 s81, s81, 1
  s_cmp_eq_u32 s81, 0
  s_cbranch_scc1 L_cwd29
  s_waitcnt vmcnt(0)
  v_cmp_ne_u32 vcc, v43, v42
  s_nop 4
  s_cbranch_vccnz L_cw29
L_cwd29:
  s_waitcnt vmcnt(0)
  s_mul_i32 s86, s51, 16384
  s_add_u32 s86, s86, 1245184
  v_lshlrev_b32 v44, 4, v0
  s_mov_b32 s81, 524288
  s_add_u32 s58, s86, 0
  buffer_load_dwordx4 v[92:95], v44, s[36:39], s58 offen sc1
  s_add_u32 s58, s86, 4096
  buffer_load_dwordx4 v[96:99], v44, s[36:39], s58 offen sc1
  s_add_u32 s58, s86, 8192
  buffer_load_dwordx4 v[100:103], v44, s[36:39], s58 offen sc1
  s_add_u32 s58, s86, 12288
  buffer_load_dwordx4 v[104:107], v44, s[36:39], s58 offen sc1
  v_and_b32 v41, 7, v1
  v_lshlrev_b32 v41, 3, v41
  s_lshl_b32 s57, s51, 6
  v_add_u32 v41, s57, v41
  global_load_dwordx2 v[112:113], v41, s[4:5]
  v_lshlrev_b32 v42, 3, v1
  v_add_u32 v43, 1024, v42
  v_min_u32 v43, 1272, v43
  global_load_dwordx2 v[116:117], v42, s[16:17]
  global_load_dwordx2 v[118:119], v42, s[16:17] offset:512
  global_load_dwordx2 v[120:121], v43, s[16:17]
  v_lshrrev_b32 v22, 3, v1
  v_lshlrev_b32 v22, 12, v22
  v_and_b32 v23, 7, v1
  v_lshlrev_b32 v23, 4, v23
  v_add_u32 v22, v22, v23
  s_lshl_b32 s87, s51, 7
  s_add_u32 s87, s87, 1900544
  global_load_dword v20, v41, s[24:25]
  v_and_b32 v45, 7, v1
  v_lshlrev_b32 v45, 4, v45
  s_lshl_b32 s57, s3, 7
  v_add_u32 v46, s57, v45
  s_waitcnt vmcnt(0)
  s_nop 0
  s_branch L_pollchk30
L_poll30:
  s_sub_u32 s81, s81, 1
  s_cmp_eq_u32 s81, 0
  s_cbranch_scc1 L_abort
  s_add_u32 s58, s86, 0
  buffer_load_dwordx4 v[92:95], v44, s[36:39], s58 offen sc1
  s_add_u32 s58, s86, 4096
  buffer_load_dwordx4 v[96:99], v44, s[36:39], s58 offen sc1
  s_add_u32 s58, s86, 8192
  buffer_load_dwordx4 v[100:103], v44, s[36:39], s58 offen sc1
  s_add_u32 s58, s86, 12288
  buffer_load_dwordx4 v[104:107], v44, s[36:39], s58 offen sc1
  s_waitcnt vmcnt(0)
L_pollchk30:
  v_perm_b32 v41, v93, v92, s56
  v_perm_b32 v42, v95, v94, s56
  v_lshl_or_b32 v41, v42, 16, v41
  v_cmp_ne_u32 vcc, v41, v3
  s_mov_b64 s[84:85], vcc
  v_perm_b32 v41, v97, v96, s56
  v_perm_b32 v42, v99, v98, s56
  v_lshl_or_b32 v41, v42, 16, v41
  v_cmp_ne_u32 vcc, v41, v3
  s_or_b64 s[84:85], s[84:85], vcc
  v_perm_b32 v41, v101, v100, s56
  v_perm_b32 v42, v103, v102, s56
  v_lshl_or_b32 v41, v42, 16, v41
  v_cmp_ne_u32 vcc, v41, v3
  s_or_b64 s[84:85], s[84:85], vcc
  v_perm_b32 v41, v105, v104, s56
  v_perm_b32 v42, v107, v106, s56
  v_lshl_or_b32 v41, v42, 16, v41
  v_cmp_ne_u32 vcc, v41, v3
  s_or_b64 s[84:85], s[84:85], vcc
  s_cmp_lg_u64 s[84:85], 0
  s_nop 2
  s_cbranch_scc1 L_poll30
  v_and_b32 v92, 0xffffff00, v92
  v_and_b32 v93, 0xffffff00, v93
  v_and_b32 v94, 0xffffff00, v94
  v_and_b32 v95, 0xffffff00, v95
  v_and_b32 v96, 0xffffff00, v96
  v_and_b32 v97, 0xffffff00, v97
  v_and_b32 v98, 0xffffff00, v98
  v_and_b32 v99, 0xffffff00, v99
  v_and_b32 v100, 0xffffff00, v100
  v_and_b32 v101, 0xffffff00, v101
  v_and_b32 v102, 0xffffff00, v102
  v_and_b32 v103, 0xffffff00, v103
  v_and_b32 v104, 0xffffff00, v104
  v_and_b32 v105, 0xffffff00, v105
  v_and_b32 v106, 0xffffff00, v106
  v_and_b32 v107, 0xffffff00, v107
  v_pk_add_f32 v[88:89], v[92:93], v[96:97]
  v_pk_add_f32 v[90:91], v[94:95], v[98:99]
  v_pk_add_f32 v[88:89], v[88:89], v[100:101]
  v_pk_add_f32 v[90:91], v[90:91], v[102:103]
  v_pk_add_f32 v[88:89], v[88:89], v[104:105]
  v_pk_add_f32 v[90:91], v[90:91], v[106:107]
  s_nop 0
  v_add_f32_dpp v88, v88, v88 row_ror:8 row_mask:0xf bank_mask:0xf
  v_add_f32_dpp v89, v89, v89 row_ror:8 row_mask:0xf bank_mask:0xf
  v_add_f32_dpp v90, v90, v90 row_ror:8 row_mask:0xf bank_mask:0xf
  v_add_f32_dpp v91, v91, v91 row_ror:8 row_mask:0xf bank_mask:0xf
  v_mov_b32 v24, v88
  v_mov_b32 v25, v89
  v_mov_b32 v26, v90
  v_mov_b32 v27, v91
  v_permlane16_swap_b32 v24, v88
  v_permlane16_swap_b32 v25, v89
  v_permlane16_swap_b32 v26, v90
  v_permlane16_swap_b32 v27, v91
  v_add_f32 v88, v88, v24
  v_add_f32 v89, v89, v25
  v_add_f32 v90, v90, v26
  v_add_f32 v91, v91, v27
  v_mov_b32 v24, v88
  v_mov_b32 v25, v89
  v_mov_b32 v26, v90
  v_mov_b32 v27, v91
  v_permlane32_swap_b32 v24, v88
  v_permlane32_swap_b32 v25, v89
  v_permlane32_swap_b32 v26, v90
  v_permlane32_swap_b32 v27, v91
  v_add_f32 v88, v88, v24
  v_add_f32 v89, v89, v25
  v_add_f32 v90, v90, v26
  v_add_f32 v91, v91, v27
  s_mov_b32 exec_lo, 0x000000ff
  s_mov_b32 exec_hi, 0x00000000
  ds_write_b128 v46, v[88:91] offset:23040
  s_mov_b64 exec, -1
  s_waitcnt lgkmcnt(0)
  s_barrier
  ds_read_b128 v[88:91], v45 offset:23040
  ds_read_b128 v[24:27], v45 offset:23168
  ds_read_b128 v[28:31], v45 offset:23296
  ds_read_b128 v[32:35], v45 offset:23424
  s_waitcnt lgkmcnt(0)
  v_pk_add_f32 v[88:89], v[88:89], v[24:25]
  v_pk_add_f32 v[90:91], v[90:91], v[26:27]
  v_pk_add_f32 v[28:29], v[28:29], v[32:33]
  v_pk_add_f32 v[30:31], v[30:31], v[34:35]
  v_pk_add_f32 v[88:89], v[88:89], v[28:29]
  v_pk_add_f32 v[90:91], v[90:91], v[30:31]
  v_lshlrev_b32 v108, 16, v112
  v_and_b32 v109, 0xffff0000, v112
  v_lshlrev_b32 v110, 16, v113
  v_and_b32 v111, 0xffff0000, v113
  v_cvt_pk_bf16_f32 v88, v88, v89
  v_cvt_pk_bf16_f32 v90, v90, v91
  v_and_b32 v89, 0xffff0000, v88
  v_lshlrev_b32 v88, 16, v88
  v_and_b32 v91, 0xffff0000, v90
  v_lshlrev_b32 v90, 16, v90
  v_pk_add_f32 v[108:109], v[108:109], v[88:89]
  v_pk_add_f32 v[110:111], v[110:111], v[90:91]
  v_cvt_pk_bf16_f32 v88, v108, v109
  v_cvt_pk_bf16_f32 v90, v110, v111
  v_and_b32 v109, 0xffff0000, v88
  v_lshlrev_b32 v108, 16, v88
  v_and_b32 v111, 0xffff0000, v90
  v_lshlrev_b32 v110, 16, v90
  v_perm_b32 v88, v108, v3, s52
  v_perm_b32 v89, v109, v3, s53
  v_perm_b32 v90, v110, v3, s54
  v_perm_b32 v91, v111, v3, s55
  s_cmp_lg_u32 s3, 0
  s_nop 0
  s_cbranch_scc1 L_rnopub
  buffer_store_dwordx4 v[88:91], v22, s[36:39], s87 offen sc1
  s_nop 1
L_rnopub:
  v_lshlrev_b32 v44, 4, v1
  v_add_u32 v45, 2048, v44
  v_min_u32 v45, 2544, v45
  s_and_b32 s86, s2, 7
  s_lshl_b32 s86, s86, 12
  s_add_u32 s86, s86, 1900544
  s_mov_b32 s81, 524288
  buffer_load_dwordx4 v[124:127], v44, s[36:39], s86 offen sc1
  buffer_load_dwordx4 v[128:131], v44, s[36:39], s86 offen offset:1024 sc1
  buffer_load_dwordx4 v[132:135], v45, s[36:39], s86 offen sc1
  s_waitcnt vmcnt(0)
  s_branch L_pollchk31
L_poll31:
  s_sub_u32 s81, s81, 1
  s_cmp_eq_u32 s81, 0
  s_cbranch_scc1 L_abort
  buffer_load_dwordx4 v[124:127], v44, s[36:39], s86 offen sc1
  buffer_load_dwordx4 v[128:131], v44, s[36:39], s86 offen offset:1024 sc1
  buffer_load_dwordx4 v[132:135], v45, s[36:39], s86 offen sc1
  s_waitcnt vmcnt(0)
L_pollchk31:
  v_perm_b32 v41, v125, v124, s56
  v_perm_b32 v42, v127, v126, s56
  v_lshl_or_b32 v41, v42, 16, v41
  v_cmp_ne_u32 vcc, v41, v3
  s_mov_b64 s[84:85], vcc
  v_perm_b32 v41, v129, v128, s56
  v_perm_b32 v42, v131, v130, s56
  v_lshl_or_b32 v41, v42, 16, v41
  v_cmp_ne_u32 vcc, v41, v3
  s_or_b64 s[84:85], s[84:85], vcc
  v_perm_b32 v41, v133, v132, s56
  v_perm_b32 v42, v135, v134, s56
  v_lshl_or_b32 v41, v42, 16, v41
  v_cmp_ne_u32 vcc, v41, v3
  s_or_b64 s[84:85], s[84:85], vcc
  s_cmp_lg_u64 s[84:85], 0
  s_nop 2
  s_cbranch_scc1 L_poll31
  v_and_b32 v124, 0xffff0000, v124
  v_and_b32 v125, 0xffff0000, v125
  v_and_b32 v126, 0xffff0000, v126
  v_and_b32 v127, 0xffff0000, v127
  v_and_b32 v128, 0xffff0000, v128
  v_and_b32 v129, 0xffff0000, v129
  v_and_b32 v130, 0xffff0000, v130
  v_and_b32 v131, 0xffff0000, v131
  v_and_b32 v132, 0xffff0000, v132
  v_and_b32 v133, 0xffff0000, v133
  v_and_b32 v134, 0xffff0000, v134
  v_and_b32 v135, 0xffff0000, v135
  v_cmp_gt_u32 vcc, 32, v1
  s_nop 1
  v_cndmask_b32 v132, 0, v132, vcc
  v_cndmask_b32 v133, 0, v133, vcc
  v_cndmask_b32 v134, 0, v134, vcc
  v_cndmask_b32 v135, 0, v135, vcc
  v_perm_b32 v136, v125, v124, s96
  v_perm_b32 v137, v127, v126, s96
  v_perm_b32 v138, v129, v128, s96
  v_perm_b32 v139, v131, v130, s96
  v_perm_b32 v140, v133, v132, s96
  v_perm_b32 v141, v135, v134, s96
  v_mov_b32 v45, 0x3f803f80
  v_dot2_f32_bf16 v41, v136, v45, 0
  v_dot2_f32_bf16 v42, v136, v136, 0
  v_dot2_f32_bf16 v41, v137, v45, v41
  v_dot2_f32_bf16 v42, v137, v137, v42
  v_dot2_f32_bf16 v41, v138, v45, v41
  v_dot2_f32_bf16 v42, v138, v138, v42
  v_dot2_f32_bf16 v41, v139, v45, v41
  v_dot2_f32_bf16 v42, v139, v139, v42
  v_dot2_f32_bf16 v41, v140, v45, v41
  v_dot2_f32_bf16 v42, v140, v140, v42
  v_dot2_f32_bf16 v41, v141, v45, v41
  v_dot2_f32_bf16 v42, v141, v141, v42
  s_nop 1
  v_add_f32_dpp v41, v41, v41 quad_perm:[1,0,3,2] row_mask:0xf bank_mask:0xf
  v_add_f32_dpp v42, v42, v42 quad_perm:[1,0,3,2] row_mask:0xf bank_mask:0xf
  s_nop 0
  v_add_f32_dpp v41, v41, v41 quad_perm:[2,3,0,1] row_mask:0xf bank_mask:0xf
  v_add_f32_dpp v42, v42, v42 quad_perm:[2,3,0,1] row_mask:0xf bank_mask:0xf
  s_nop 0
  v_add_f32_dpp v41, v41, v41 row_half_mirror row_mask:0xf bank_mask:0xf
  v_add_f32_dpp v42, v42, v42 row_half_mirror row_mask:0xf bank_mask:0xf
  s_nop 0
  v_add_f32_dpp v41, v41, v41 row_mirror row_mask:0xf bank_mask:0xf
  v_add_f32_dpp v42, v42, v42 row_mirror row_mask:0xf bank_mask:0xf
  v_mov_b32 v43, v41
  v_mov_b32 v44, v42
  s_nop 0
  v_permlane16_swap_b32 v43, v41
  v_permlane16_swap_b32 v44, v42
  v_add_f32 v41, v41, v43
  v_add_f32 v42, v42, v44
  v_mov_b32 v43, v41
  v_mov_b32 v44, v42
  s_nop 0
  v_permlane32_swap_b32 v43, v41
  v_permlane32_swap_b32 v44, v42
  v_add_f32 v41, v41, v43
  v_add_f32 v42, v42, v44
  v_mul_f32 v41, 0x3acccccd, v41
  v_mul_f32 v42, 0x3acccccd, v42
  v_fma_f32 v42, -v41, v41, v42
  v_max_f32 v42, 0, v42
  v_cvt_pk_bf16_f32 v42, v42, v42
  v_lshlrev_b32 v42, 16, v42
  v_add_f32 v42, 0x3727c5ac, v42
  v_cvt_pk_bf16_f32 v42, v42, v42
  v_lshlrev_b32 v42, 16, v42
  v_cvt_pk_bf16_f32 v41, v41, v41
  v_lshlrev_b32 v41, 16, v41
  v_sqrt_f32 v42, v42
  s_nop 0
  v_cvt_pk_bf16_f32 v42, v42, v42
  v_lshlrev_b32 v42, 16, v42
  v_rcp_f32 v45, v42
  v_sub_f32 v124, v124, v41
  v_sub_f32 v125, v125, v41
  v_cvt_pk_bf16_f32 v43, v124, v125
  v_lshlrev_b32 v124, 16, v43
  v_and_b32 v125, 0xffff0000, v43
  v_mul_f32 v124, v124, v45
  v_mul_f32 v125, v125, v45
  v_cvt_pk_bf16_f32 v136, v124, v125
  v_lshlrev_b32 v124, 16, v136
  v_and_b32 v125, 0xffff0000, v136
  v_sub_f32 v126, v126, v41
  v_sub_f32 v127, v127, v41
  v_cvt_pk_bf16_f32 v43, v126, v127
  v_lshlrev_b32 v126, 16, v43
  v_and_b32 v127, 0xffff0000, v43
  v_mul_f32 v126, v126, v45
  v_mul_f32 v127, v127, v45
  v_cvt_pk_bf16_f32 v137, v126, v127
  v_lshlrev_b32 v126, 16, v137
  v_and_b32 v127, 0xffff0000, v137
  v_sub_f32 v128, v128, v41
  v_sub_f32 v129, v129, v41
  v_cvt_pk_bf16_f32 v43, v128, v129
  v_lshlrev_b32 v128, 16, v43
  v_and_b32 v129, 0xffff0000, v43
  v_mul_f32 v128, v128, v45
  v_mul_f32 v129, v129, v45
  v_cvt_pk_bf16_f32 v138, v128, v129
  v_lshlrev_b32 v128, 16, v138
  v_and_b32 v129, 0xffff0000, v138
  v_sub_f32 v130, v130, v41
  v_sub_f32 v131, v131, v41
  v_cvt_pk_bf16_f32 v43, v130, v131
  v_lshlrev_b32 v130, 16, v43
  v_and_b32 v131, 0xffff0000, v43
  v_mul_f32 v130, v130, v45
  v_mul_f32 v131, v131, v45
  v_cvt_pk_bf16_f32 v139, v130, v131
  v_lshlrev_b32 v130, 16, v139
  v_and_b32 v131, 0xffff0000, v139
  v_sub_f32 v132, v132, v41
  v_sub_f32 v133, v133, v41
  v_cvt_pk_bf16_f32 v43, v132, v133
  v_lshlrev_b32 v132, 16, v43
  v_and_b32 v133, 0xffff0000, v43
  v_mul_f32 v132, v132, v45
  v_mul_f32 v133, v133, v45
  v_cvt_pk_bf16_f32 v140, v132, v133
  v_lshlrev_b32 v132, 16, v140
  v_and_b32 v133, 0xffff0000, v140
  v_sub_f32 v134, v134, v41
  v_sub_f32 v135, v135, v41
  v_cvt_pk_bf16_f32 v43, v134, v135
  v_lshlrev_b32 v134, 16, v43
  v_and_b32 v135, 0xffff0000, v43
  v_mul_f32 v134, v134, v45
  v_mul_f32 v135, v135, v45
  v_cvt_pk_bf16_f32 v141, v134, v135
  v_lshlrev_b32 v134, 16, v141
  v_and_b32 v135, 0xffff0000, v141
  v_cmp_gt_u32 vcc, 32, v1
  s_nop 1
  v_cndmask_b32 v120, 0, v120, vcc
  v_cndmask_b32 v121, 0, v121, vcc
  v_dot2_f32_bf16 v41, v136, v116, 0
  v_dot2_f32_bf16 v41, v137, v117, v41
  v_dot2_f32_bf16 v41, v138, v118, v41
  v_dot2_f32_bf16 v41, v139, v119, v41
  v_dot2_f32_bf16 v41, v140, v120, v41
  v_dot2_f32_bf16 v41, v141, v121, v41
  s_nop 2
  v_add_f32_dpp v41, v41, v41 quad_perm:[1,0,3,2] row_mask:0xf bank_mask:0xf
  s_nop 1
  v_add_f32_dpp v41, v41, v41 quad_perm:[2,3,0,1] row_mask:0xf bank_mask:0xf
  s_nop 1
  v_add_f32_dpp v41, v41, v41 row_half_mirror row_mask:0xf bank_mask:0xf
  s_nop 1
  v_add_f32_dpp v41, v41, v41 row_mirror row_mask:0xf bank_mask:0xf
  v_mov_b32 v42, v41
  s_nop 1
  v_permlane16_swap_b32 v42, v41
  v_add_f32 v41, v41, v42
  v_mov_b32 v42, v41
  s_nop 1
  v_permlane32_swap_b32 v42, v41
  v_add_f32 v41, v41, v42
  v_cvt_pk_bf16_f32 v41, v41, v41
  v_lshlrev_b32 v41, 16, v41
  v_mul_f32 v42, 0xbfb8aa3b, v41
  v_min_f32 v42, 0x42fc0000, v42
  v_exp_f32 v42, v42
  s_nop 0
  v_add_f32 v42, 1.0, v42
  v_rcp_f32 v43, v42
  s_nop 0
  v_cvt_pk_bf16_f32 v20, v43, v43
  v_lshlrev_b32 v20, 16, v20
  s_lshl_b32 s57, s51, 3
  s_lshr_b32 s58, s57, 6
  s_and_b32 s57, s57, 63
  v_and_b32 v41, 7, v1
  v_add_u32 v41, s57, v41
  v_lshlrev_b32 v41, 2, v41
  v_mov_b32 v16, v124
  v_mov_b32 v17, v125
  v_mov_b32 v18, v126
  v_mov_b32 v19, v127
  s_cmp_eq_u32 s58, 0
  s_nop 0
  s_cbranch_scc1 L_hs
  v_mov_b32 v16, v128
  v_mov_b32 v17, v129
  v_mov_b32 v18, v130
  v_mov_b32 v19, v131
  s_cmp_eq_u32 s58, 1
  s_nop 0
  s_cbranch_scc1 L_hs
  v_mov_b32 v16, v132
  v_mov_b32 v17, v133
  v_mov_b32 v18, v134
  v_mov_b32 v19, v135
  s_nop 1
L_hs:
  ds_bpermute_b32 v16, v41, v16
  ds_bpermute_b32 v17, v41, v17
  ds_bpermute_b32 v18, v41, v18
  ds_bpermute_b32 v19, v41, v19
  s_waitcnt lgkmcnt(0)
  s_mul_i32 s86, s51, 12288
  s_add_u32 s86, s86, 1576960
  v_lshlrev_b32 v44, 4, v0
  s_mov_b32 s81, 524288
  s_add_u32 s58, s86, 0
  buffer_load_dwordx4 v[92:95], v44, s[36:39], s58 offen sc1
  s_add_u32 s58, s86, 4096
  buffer_load_dwordx4 v[96:99], v44, s[36:39], s58 offen sc1
  s_add_u32 s58, s86, 8192
  buffer_load_dwordx4 v[100:103], v44, s[36:39], s58 offen sc1
  v_lshlrev_b32 v21, 3, v1
  s_lshl_b32 s57, s51, 6
  v_add_u32 v21, s57, v21
  v_and_b32 v45, 7, v1
  v_lshlrev_b32 v45, 4, v45
  s_lshl_b32 s57, s3, 7
  v_add_u32 v46, s57, v45
  s_waitcnt vmcnt(0)
  s_nop 0
  s_branch L_pollchk32
L_poll32:
  s_sub_u32 s81, s81, 1
  s_cmp_eq_u32 s81, 0
  s_cbranch_scc1 L_abort
  s_add_u32 s58, s86, 0
  buffer_load_dwordx4 v[92:95], v44, s[36:39], s58 offen sc1
  s_add_u32 s58, s86, 4096
  buffer_load_dwordx4 v[96:99], v44, s[36:39], s58 offen sc1
  s_add_u32 s58, s86, 8192
  buffer_load_dwordx4 v[100:103], v44, s[36:39], s58 offen sc1
  s_waitcnt vmcnt(0)
L_pollchk32:
  v_perm_b32 v41, v93, v92, s56
  v_perm_b32 v42, v95, v94, s56
  v_lshl_or_b32 v41, v42, 16, v41
  v_cmp_ne_u32 vcc, v41, v3
  s_mov_b64 s[84:85], vcc
  v_perm_b32 v41, v97, v96, s56
  v_perm_b32 v42, v99, v98, s56
  v_lshl_or_b32 v41, v42, 16, v41
  v_cmp_ne_u32 vcc, v41, v3
  s_or_b64 s[84:85], s[84:85], vcc
  v_perm_b32 v41, v101, v100, s56
  v_perm_b32 v42, v103, v102, s56
  v_lshl_or_b32 v41, v42, 16, v41
  v_cmp_ne_u32 vcc, v41, v3
  s_or_b64 s[84:85], s[84:85], vcc
  s_cmp_lg_u64 s[84:85], 0
  s_nop 2
  s_cbranch_scc1 L_poll32
  v_and_b32 v92, 0xffffff00, v92
  v_and_b32 v93, 0xffffff00, v93
  v_and_b32 v94, 0xffffff00, v94
  v_and_b32 v95, 0xffffff00, v95
  v_and_b32 v96, 0xffffff00, v96
  v_and_b32 v97, 0xffffff00, v97
  v_and_b32 v98, 0xffffff00, v98
  v_and_b32 v99, 0xffffff00, v99
  v_and_b32 v100, 0xffffff00, v100
  v_and_b32 v101, 0xffffff00, v101
  v_and_b32 v102, 0xffffff00, v102
  v_and_b32 v103, 0xffffff00, v103
  v_pk_add_f32 v[88:89], v[92:93], v[96:97]
  v_pk_add_f32 v[90:91], v[94:95], v[98:99]
  v_pk_add_f32 v[88:89], v[88:89], v[100:101]
  v_pk_add_f32 v[90:91], v[90:91], v[102:103]
  s_nop 0
  v_add_f32_dpp v88, v88, v88 row_ror:8 row_mask:0xf bank_mask:0xf
  v_add_f32_dpp v89, v89, v89 row_ror:8 row_mask:0xf bank_mask:0xf
  v_add_f32_dpp v90, v90, v90 row_ror:8 row_mask:0xf bank_mask:0xf
  v_add_f32_dpp v91, v91, v91 row_ror:8 row_mask:0xf bank_mask:0xf
  v_mov_b32 v24, v88
  v_mov_b32 v25, v89
  v_mov_b32 v26, v90
  v_mov_b32 v27, v91
  v_permlane16_swap_b32 v24, v88
  v_permlane16_swap_b32 v25, v89
  v_permlane16_swap_b32 v26, v90
  v_permlane16_swap_b32 v27, v91
  v_add_f32 v88, v88, v24
  v_add_f32 v89, v89, v25
  v_add_f32 v90, v90, v26
  v_add_f32 v91, v91, v27
  v_mov_b32 v24, v88
  v_mov_b32 v25, v89
  v_mov_b32 v26, v90
  v_mov_b32 v27, v91
  v_permlane32_swap_b32 v24, v88
  v_permlane32_swap_b32 v25, v89
  v_permlane32_swap_b32 v26, v90
  v_permlane32_swap_b32 v27, v91
  v_add_f32 v88, v88, v24
  v_add_f32 v89, v89, v25
  v_add_f32 v90, v90, v26
  v_add_f32 v91, v91, v27
  s_mov_b32 exec_lo, 0x000000ff
  s_mov_b32 exec_hi, 0x00000000
  ds_write_b128 v46, v[88:91] offset:12800
  s_mov_b64 exec, -1
  s_waitcnt lgkmcnt(0)
  s_barrier
  ds_read_b128 v[88:91], v45 offset:12800
  ds_read_b128 v[24:27], v45 offset:12928
  ds_read_b128 v[28:31], v45 offset:13056
  ds_read_b128 v[32:35], v45 offset:13184
  s_waitcnt lgkmcnt(0)
  v_pk_add_f32 v[88:89], v[88:89], v[24:25]
  v_pk_add_f32 v[90:91], v[90:91], v[26:27]
  v_pk_add_f32 v[28:29], v[28:29], v[32:33]
  v_pk_add_f32 v[30:31], v[30:31], v[34:35]
  v_pk_add_f32 v[88:89], v[88:89], v[28:29]
  v_pk_add_f32 v[90:91], v[90:91], v[30:31]
  v_cvt_pk_bf16_f32 v88, v88, v89
  v_cvt_pk_bf16_f32 v90, v90, v91
  v_and_b32 v89, 0xffff0000, v88
  v_lshlrev_b32 v88, 16, v88
  v_and_b32 v91, 0xffff0000, v90
  v_lshlrev_b32 v90, 16, v90
  v_mul_f32 v88, v88, v20
  v_mul_f32 v89, v89, v20
  v_mul_f32 v90, v90, v20
  v_mul_f32 v91, v91, v20
  v_cvt_pk_bf16_f32 v88, v88, v89
  v_cvt_pk_bf16_f32 v90, v90, v91
  v_and_b32 v89, 0xffff0000, v88
  v_lshlrev_b32 v88, 16, v88
  v_and_b32 v91, 0xffff0000, v90
  v_lshlrev_b32 v90, 16, v90
  v_pk_add_f32 v[88:89], v[88:89], v[16:17]
  v_pk_add_f32 v[90:91], v[90:91], v[18:19]
  v_cvt_pk_bf16_f32 v88, v88, v89
  v_cvt_pk_bf16_f32 v90, v90, v91
  v_and_b32 v89, 0xffff0000, v88
  v_lshlrev_b32 v88, 16, v88
  v_and_b32 v91, 0xffff0000, v90
  v_lshlrev_b32 v90, 16, v90
  v_pk_add_f32 v[88:89], v[88:89], v[108:109]
  v_pk_add_f32 v[90:91], v[90:91], v[110:111]
  v_cvt_pk_bf16_f32 v88, v88, v89
  v_cvt_pk_bf16_f32 v89, v90, v91
  s_cmp_lg_u32 s3, 0
  s_nop 0
  s_cbranch_scc1 L_fin
  s_mov_b32 exec_lo, 0x000000ff
  s_mov_b32 exec_hi, 0x00000000
  global_store_dwordx2 v21, v[88:89], s[24:25]
  s_cmp_lg_u32 s51, 0
  s_cbranch_scc1 L_fin
  s_mov_b64 exec, 1
  v_mov_b32 v42, 0
  buffer_store_dword v3, v42, s[36:39], 0 offen offset:0
  s_nop 0
L_fin:
L_abort:
L_end:
  s_endpgm
L_codeend:
.section .rodata,"a"
.p2align 6
.amdhsa_kernel sequential_preLN__mha_block_cached__moe_arch_mod__decode_kernel
  .amdhsa_next_free_vgpr 240
  .amdhsa_next_free_sgpr 100
  .amdhsa_accum_offset 240
  .amdhsa_group_segment_fixed_size 0
  .amdhsa_kernarg_size 104
  .amdhsa_user_sgpr_count 2
  .amdhsa_user_sgpr_kernarg_segment_ptr 1
  .amdhsa_system_sgpr_workgroup_id_x 1
.end_amdhsa_kernel
```
